```python
import torch

def _softmax(x, axis=-1):
    return torch.softmax(x, dim=axis)
def _gelu(x):
    return torch.nn.functional.gelu(x, approximate="tanh")
def _silu(x):
    return torch.nn.functional.silu(x)
def _sigmoid(x):
    return torch.sigmoid(x)
def _layernorm(x, axis=-1, eps=1e-5):
    m = x.mean(dim=axis, keepdim=True)
    v = x.var(dim=axis, keepdim=True, unbiased=False)
    return (x - m) / torch.sqrt(v + eps)
def _scatter_add(tgt, idx, src, axis=0):
    return tgt.clone().index_add_(axis, idx, src)
def _segment_sum(src, seg, n):
    out = torch.zeros((n,) + src.shape[1:], dtype=src.dtype)
    return out.index_add_(0, seg, src)
def _pad(x, pw):
    flat = tuple(v for pair in reversed(pw) for v in pair)
    return torch.nn.functional.pad(x, flat)

kernel_name = 'concat_heads__mha_block_cached__mha_block_cached__near_ridge'

def setup_inputs():

    _w = (lambda a: (lambda t: t.to(torch.bfloat16) if t.is_floating_point() else t)(torch.as_tensor(a)))
    def _A_setup():
        B, Sq, D = 8, 112, 1024
        H, Sk, Dh = 32, 512, 128
        return {
            "x": _w((lambda *s: torch.randn(*s, dtype=torch.bfloat16) * 0.8)(B, Sq, D)),
            "k_cache": _w((lambda *s: torch.randn(*s, dtype=torch.bfloat16) * 0.8)(B, H, Sk, Dh)),
            "v_cache": _w((lambda *s: torch.randn(*s, dtype=torch.bfloat16) * 0.05)(B, H, Sk, Dh)),
            "wq": _w((lambda *s: torch.randn(*s, dtype=torch.bfloat16) * 0.8)(D, H * Dh) * (D ** -0.5)),
            "wo": _w((lambda *s: torch.randn(*s, dtype=torch.bfloat16) * 0.05)(H * Dh, D) * ((H * Dh) ** -0.5)),
        }
    _A_in = _A_setup()

    def _B_setup():
        B, Sq, D = 8, 112, 1024
        H, Sk, Dh = 32, 512, 128
        return {
            "x": _w((lambda *s: torch.randn(*s, dtype=torch.bfloat16) * 0.8)(B, Sq, D)),
            "k_cache": _w((lambda *s: torch.randn(*s, dtype=torch.bfloat16) * 0.8)(B, H, Sk, Dh)),
            "v_cache": _w((lambda *s: torch.randn(*s, dtype=torch.bfloat16) * 0.05)(B, H, Sk, Dh)),
            "wq": _w((lambda *s: torch.randn(*s, dtype=torch.bfloat16) * 0.8)(D, H * Dh) * (D ** -0.5)),
            "wo": _w((lambda *s: torch.randn(*s, dtype=torch.bfloat16) * 0.05)(H * Dh, D) * ((H * Dh) ** -0.5)),
        }
    _B_in = _B_setup()

    return {
        "A_x": _A_in["x"],
        "A_k_cache": _A_in["k_cache"],
        "A_v_cache": _A_in["v_cache"],
        "A_wq": _A_in["wq"],
        "A_wo": _A_in["wo"],
        "B_x": _B_in["x"],
        "B_k_cache": _B_in["k_cache"],
        "B_v_cache": _B_in["v_cache"],
        "B_wq": _B_in["wq"],
        "B_wo": _B_in["wo"],
    }

def reference(A_x, A_k_cache, A_v_cache, A_wq, A_wo, B_x, B_k_cache, B_v_cache, B_wq, B_wo):
    def _A_ref(x, k_cache, v_cache, wq, wo):
        B, Sq, D = x.shape
        H, Dh = 32, 128
        q = (lambda x, *d: x.permute(*d))((x @ wq).reshape(B, Sq, H, Dh), 0, 2, 1, 3)
        scores = torch.einsum("bhqd,bhkd->bhqk", q, k_cache) * (Dh ** -0.5)
        p = _softmax(scores, axis=-1)
        o = torch.einsum("bhqk,bhkd->bhqd", p, v_cache)
        return (lambda x, *d: x.permute(*d))(o, 0, 2, 1, 3).reshape(B, Sq, H * Dh) @ wo

    def _B_ref(x, k_cache, v_cache, wq, wo):
        B, Sq, D = x.shape
        H, Dh = 32, 128
        q = (lambda x, *d: x.permute(*d))((x @ wq).reshape(B, Sq, H, Dh), 0, 2, 1, 3)
        scores = torch.einsum("bhqd,bhkd->bhqk", q, k_cache) * (Dh ** -0.5)
        p = _softmax(scores, axis=-1)
        o = torch.einsum("bhqk,bhkd->bhqd", p, v_cache)
        return (lambda x, *d: x.permute(*d))(o, 0, 2, 1, 3).reshape(B, Sq, H * Dh) @ wo

    a = _A_ref(A_x, A_k_cache, A_v_cache, A_wq, A_wo)
    b = _B_ref(B_x, B_k_cache, B_v_cache, B_wq, B_wo)
    return torch.concatenate([a, b], axis=-1)
```

```asm
; @launch kernel=attn_kernel grid=(256,1,1) block=(512,1,1) lds=163840
.amdgcn_target "amdgcn-amd-amdhsa--gfx950"
.text
.globl attn_kernel
.p2align 8
.type attn_kernel,@function
attn_kernel:
    s_cmp_ge_u32 s2, 256
    s_cbranch_scc1 L_attn_end
    s_and_b32 s4, s2, 7
    s_lshr_b32 s5, s2, 3
    s_lshr_b32 s6, s4, 2
    s_and_b32 s7, s4, 3
    s_lshl_b32 s7, s7, 2
    s_and_b32 s8, s5, 3
    s_add_u32 s7, s7, s8
    s_lshr_b32 s8, s5, 2
    s_mul_i32 s9, s6, 40
    s_add_u32 s10, s0, s9
    s_addc_u32 s11, s1, 0
    s_load_dwordx8 s[12:19], s[10:11], 0
    s_load_dwordx2 s[94:95], s[10:11], 32
    s_load_dwordx2 s[52:53], s[0:1], 96
    v_and_b32 v1, 63, v0
    v_lshrrev_b32 v2, 6, v0
    s_nop 0
    v_readfirstlane_b32 s3, v2
    s_mov_b32 s47, 0x3e0293ee
    s_mov_b32 s100, 0x3e0293ee
    s_mov_b32 s101, 0x3e0293ee
    v_lshrrev_b32 v36, 4, v1
    v_and_b32 v37, 15, v1
    v_bfe_u32 v38, v1, 2, 2
    v_and_b32 v39, 3, v1
    v_lshrrev_b32 v42, 5, v1
    v_and_b32 v43, 31, v1
    s_and_b32 s99, s3, 3
    s_lshr_b32 s96, s3, 2
    s_lshl_b32 s42, s3, 12
    s_lshl_b32 s92, s3, 11
    s_add_u32 s93, s92, 131072
    s_add_u32 s92, s92, 65536
    v_lshlrev_b32 v41, 2, v42
    v_xor_b32 v41, v41, v37
    v_lshlrev_b32 v41, 4, v41
    v_lshl_add_u32 v41, v42, 13, v41
    v_and_b32 v40, 1, v36
    v_lshl_add_u32 v41, v40, 8, v41
    s_lshl_b32 s48, s3, 15
    v_add_u32 v2, s48, v41
    v_xor_b32 v41, 128, v2
    v_add_u32 v3, 15360, v41
    v_and_b32 v41, 7, v1
    v_xor_b32 v40, v36, v41
    v_lshlrev_b32 v40, 4, v40
    v_lshrrev_b32 v41, 3, v1
    v_lshl_add_u32 v40, v41, 11, v40
    v_add_u32 v4, s48, v40
    v_xor_b32 v40, 64, v4
    v_add_u32 v5, 15360, v40
    s_waitcnt lgkmcnt(0)
    s_mul_i32 s9, s8, 229376
    s_add_u32 s20, s12, s9
    s_addc_u32 s21, s13, 0
    s_mov_b32 s22, 229376
    s_mov_b32 s23, 0x00020000
    s_lshl_b32 s9, s7, 9
    s_add_u32 s24, s18, s9
    s_addc_u32 s25, s19, 0
    s_sub_u32 s26, 8388608, s9
    s_mov_b32 s27, 0x00020000
    s_mov_b32 s43, 0
    s_mov_b32 s44, 0
    s_add_u32 m0, s93, 0
    s_nop 0
    buffer_load_dwordx4 v4, s[20:23], s44 offen  lds
    s_add_u32 m0, s93, 0
    s_nop 0
    buffer_load_dwordx4 v5, s[20:23], s44 offen offset:1024  lds
    s_add_u32 s44, s44, 128
    s_add_u32 m0, s92, 0
    s_nop 0
    buffer_load_dwordx4 v2, s[24:27], s43 offen nt lds
    s_add_u32 m0, s92, 0
    s_nop 0
    buffer_load_dwordx4 v3, s[24:27], s43 offen offset:1024 nt lds
    s_add_u32 s43, s43, 262144
    s_add_u32 m0, s92, 16384
    s_nop 0
    buffer_load_dwordx4 v2, s[24:27], s43 offen nt lds
    s_add_u32 m0, s92, 16384
    s_nop 0
    buffer_load_dwordx4 v3, s[24:27], s43 offen offset:1024 nt lds
    s_add_u32 s43, s43, 262144
    s_add_u32 m0, s93, 16384
    s_nop 0
    buffer_load_dwordx4 v4, s[20:23], s44 offen  lds
    s_add_u32 m0, s93, 16384
    s_nop 0
    buffer_load_dwordx4 v5, s[20:23], s44 offen offset:1024  lds
    s_add_u32 s44, s44, 128
    s_add_u32 m0, s92, 32768
    s_nop 0
    buffer_load_dwordx4 v2, s[24:27], s43 offen nt lds
    s_add_u32 m0, s92, 32768
    s_nop 0
    buffer_load_dwordx4 v3, s[24:27], s43 offen offset:1024 nt lds
    s_add_u32 s43, s43, 262144
    s_add_u32 m0, s92, 49152
    s_nop 0
    buffer_load_dwordx4 v2, s[24:27], s43 offen nt lds
    s_add_u32 m0, s92, 49152
    s_nop 0
    buffer_load_dwordx4 v3, s[24:27], s43 offen offset:1024 nt lds
    s_add_u32 s43, s43, 262144
    v_bfe_u32 v40, v43, 1, 3
    v_xor_b32 v40, v40, v42
    v_lshlrev_b32 v40, 4, v40
    v_lshl_add_u32 v40, v43, 7, v40
    s_lshl_b32 s48, s99, 12
    s_add_u32 s48, s48, 131072
    v_add_u32 v18, s48, v40
    v_xor_b32 v19, 32, v18
    v_xor_b32 v20, 64, v18
    v_xor_b32 v21, 96, v18
    v_and_b32 v40, 1, v36
    v_and_b32 v41, 1, v39
    v_lshl_or_b32 v40, v40, 1, v41
    v_lshl_or_b32 v40, v38, 2, v40
    v_lshlrev_b32 v40, 4, v40
    v_lshrrev_b32 v41, 1, v39
    v_lshl_or_b32 v40, v41, 3, v40
    v_lshl_add_u32 v41, v42, 3, v38
    v_lshl_add_u32 v40, v41, 9, v40
    s_lshl_b32 s48, s96, 8
    s_add_u32 s48, s48, 65536
    v_add_u32 v14, s48, v40
    v_xor_b32 v15, 64, v14
    v_xor_b32 v16, 128, v14
    v_xor_b32 v17, 192, v14
    s_lshl_b32 s48, s99, 12
    v_xor_b32 v40, v36, v37
    v_lshlrev_b32 v40, 4, v40
    v_lshl_add_u32 v40, v36, 8, v40
    v_add_u32 v6, s48, v40
    v_xor_b32 v7, 64, v6
    v_xor_b32 v8, 128, v6
    v_xor_b32 v9, 192, v6
    v_lshlrev_b32 v40, 2, v36
    v_xor_b32 v40, v40, v37
    v_lshlrev_b32 v40, 4, v40
    v_lshl_add_u32 v40, v36, 8, v40
    v_add_u32 v10, s48, v40
    s_lshl_b32 s49, s96, 14
    v_xor_b32 v40, v42, v37
    v_lshlrev_b32 v40, 4, v40
    v_lshl_add_u32 v40, v43, 8, v40
    v_add_u32 v11, s49, v40
    v_and_b32 v40, 1, v36
    v_lshrrev_b32 v41, 1, v39
    v_lshl_or_b32 v40, v40, 1, v41
    v_lshl_or_b32 v40, v38, 2, v40
    v_lshlrev_b32 v40, 4, v40
    v_and_b32 v41, 1, v39
    v_lshl_or_b32 v40, v41, 3, v40
    v_lshl_add_u32 v41, v42, 2, v38
    v_lshl_add_u32 v40, v41, 8, v40
    v_add_u32 v12, s49, v40
    v_and_b32 v40, 1, v36
    v_lshlrev_b32 v40, 10, v40
    v_lshl_add_u32 v40, v42, 8, v40
    v_lshl_add_u32 v40, v37, 4, v40
    s_lshl_b32 s48, s99, 11
    v_add_u32 v40, s48, v40
    v_mov_b32 v41, 0x40000000
    v_cmp_gt_u32 vcc, 7168, v40
    s_nop 1
    v_cndmask_b32 v13, v41, v40, vcc
    v_lshlrev_b32 v27, 4, v1
    s_lshl_b32 s7, s7, 1
    s_add_u32 s7, s7, s96
    s_lshl_b32 s9, s8, 5
    s_add_u32 s9, s9, s7
    s_lshl_b32 s10, s9, 15
    s_lshl_b32 s9, s9, 17
    s_add_u32 s28, s14, s9
    s_addc_u32 s29, s15, 0
    s_mov_b32 s30, 131072
    s_mov_b32 s31, 0x00020000
    s_add_u32 s32, s16, s9
    s_addc_u32 s33, s17, 0
    s_mov_b32 s34, 131072
    s_mov_b32 s35, 0x00020000
    s_add_u32 s56, s94, s10
    s_addc_u32 s57, s95, 0
    s_mov_b32 s58, 32768
    s_mov_b32 s59, 0x00020000
    s_lshl_b32 s9, s6, 3
    s_add_u32 s9, s9, s8
    s_lshl_b32 s9, s9, 7
    s_lshl_b32 s10, s7, 2
    s_add_u32 s9, s9, s10
    s_mul_i32 s9, s9, 7168
    s_add_u32 s36, s52, s9
    s_addc_u32 s37, s53, 0
    s_mov_b32 s38, 28672
    s_mov_b32 s39, 0x00020000
    s_mov_b32 s40, 0
    s_mov_b32 s41, 131072
    s_mov_b32 s45, 32768
    v_mov_b32 v64, 0
    v_mov_b32 v65, 0
    v_mov_b32 v66, 0
    v_mov_b32 v67, 0
    v_mov_b32 v68, 0
    v_mov_b32 v69, 0
    v_mov_b32 v70, 0
    v_mov_b32 v71, 0
    v_mov_b32 v72, 0
    v_mov_b32 v73, 0
    v_mov_b32 v74, 0
    v_mov_b32 v75, 0
    v_mov_b32 v76, 0
    v_mov_b32 v77, 0
    v_mov_b32 v78, 0
    v_mov_b32 v79, 0
    v_mov_b32 v80, 0
    v_mov_b32 v81, 0
    v_mov_b32 v82, 0
    v_mov_b32 v83, 0
    v_mov_b32 v84, 0
    v_mov_b32 v85, 0
    v_mov_b32 v86, 0
    v_mov_b32 v87, 0
    v_mov_b32 v88, 0
    v_mov_b32 v89, 0
    v_mov_b32 v90, 0
    v_mov_b32 v91, 0
    v_mov_b32 v92, 0
    v_mov_b32 v93, 0
    v_mov_b32 v94, 0
    v_mov_b32 v95, 0
    v_mov_b32 v96, 0
    v_mov_b32 v97, 0
    v_mov_b32 v98, 0
    v_mov_b32 v99, 0
    v_mov_b32 v100, 0
    v_mov_b32 v101, 0
    v_mov_b32 v102, 0
    v_mov_b32 v103, 0
    v_mov_b32 v104, 0
    v_mov_b32 v105, 0
    v_mov_b32 v106, 0
    v_mov_b32 v107, 0
    v_mov_b32 v108, 0
    v_mov_b32 v109, 0
    v_mov_b32 v110, 0
    v_mov_b32 v111, 0
    v_mov_b32 v112, 0
    v_mov_b32 v113, 0
    v_mov_b32 v114, 0
    v_mov_b32 v115, 0
    v_mov_b32 v116, 0
    v_mov_b32 v117, 0
    v_mov_b32 v118, 0
    v_mov_b32 v119, 0
    v_mov_b32 v120, 0
    v_mov_b32 v121, 0
    v_mov_b32 v122, 0
    v_mov_b32 v123, 0
    v_mov_b32 v124, 0
    v_mov_b32 v125, 0
    v_mov_b32 v126, 0
    v_mov_b32 v127, 0
    s_waitcnt vmcnt(8)
    s_barrier
    ds_read_b128 v[192:195], v18 offset:0
    ds_read_b128 v[196:199], v19 offset:0
    ds_read_b128 v[200:203], v20 offset:0
    ds_read_b128 v[204:207], v21 offset:0
    ds_read_b64_tr_b16 v[128:129], v14 offset:0
    ds_read_b64_tr_b16 v[130:131], v14 offset:2048
    ds_read_b64_tr_b16 v[132:133], v15 offset:0
    ds_read_b64_tr_b16 v[134:135], v15 offset:2048
    ds_read_b64_tr_b16 v[136:137], v16 offset:0
    ds_read_b64_tr_b16 v[138:139], v16 offset:2048
    ds_read_b64_tr_b16 v[140:141], v17 offset:0
    ds_read_b64_tr_b16 v[142:143], v17 offset:2048
    ds_read_b64_tr_b16 v[144:145], v14 offset:8192
    ds_read_b64_tr_b16 v[146:147], v14 offset:10240
    ds_read_b64_tr_b16 v[148:149], v15 offset:8192
    ds_read_b64_tr_b16 v[150:151], v15 offset:10240
    ds_read_b64_tr_b16 v[152:153], v16 offset:8192
    ds_read_b64_tr_b16 v[154:155], v16 offset:10240
    ds_read_b64_tr_b16 v[156:157], v17 offset:8192
    ds_read_b64_tr_b16 v[158:159], v17 offset:10240
    s_lshl_b32 s98, s99, 13
    s_mov_b32 s46, 0
L_qp_loop:
    s_waitcnt vmcnt(6) lgkmcnt(0)
    s_barrier
    v_mfma_f32_32x32x16_bf16 v[64:79], v[128:131], v[192:195], v[64:79]
    ds_read_b64_tr_b16 v[160:161], v14 offset:16384
    ds_read_b64_tr_b16 v[162:163], v14 offset:18432
    ds_read_b64_tr_b16 v[164:165], v15 offset:16384
    ds_read_b64_tr_b16 v[166:167], v15 offset:18432
    s_add_u32 m0, s93, 0
    s_nop 0
    buffer_load_dwordx4 v4, s[20:23], s44 offen  lds
    v_mfma_f32_32x32x16_bf16 v[80:95], v[132:135], v[192:195], v[80:95]
    ds_read_b64_tr_b16 v[168:169], v16 offset:16384
    ds_read_b64_tr_b16 v[170:171], v16 offset:18432
    ds_read_b64_tr_b16 v[172:173], v17 offset:16384
    ds_read_b64_tr_b16 v[174:175], v17 offset:18432
    v_mfma_f32_32x32x16_bf16 v[96:111], v[136:139], v[192:195], v[96:111]
    ds_read_b64_tr_b16 v[176:177], v14 offset:24576
    ds_read_b64_tr_b16 v[178:179], v14 offset:26624
    ds_read_b64_tr_b16 v[180:181], v15 offset:24576
    ds_read_b64_tr_b16 v[182:183], v15 offset:26624
    s_add_u32 m0, s93, 0
    s_nop 0
    buffer_load_dwordx4 v5, s[20:23], s44 offen offset:1024  lds
    s_add_u32 s44, s44, 128
    v_mfma_f32_32x32x16_bf16 v[112:127], v[140:143], v[192:195], v[112:127]
    ds_read_b64_tr_b16 v[184:185], v16 offset:24576
    ds_read_b64_tr_b16 v[186:187], v16 offset:26624
    ds_read_b64_tr_b16 v[188:189], v17 offset:24576
    ds_read_b64_tr_b16 v[190:191], v17 offset:26624
    v_mfma_f32_32x32x16_bf16 v[64:79], v[144:147], v[196:199], v[64:79]
    s_add_u32 m0, s92, 0
    s_nop 0
    buffer_load_dwordx4 v2, s[24:27], s43 offen nt lds
    v_mfma_f32_32x32x16_bf16 v[80:95], v[148:151], v[196:199], v[80:95]
    v_mfma_f32_32x32x16_bf16 v[96:111], v[152:155], v[196:199], v[96:111]
    s_add_u32 m0, s92, 0
    s_nop 0
    buffer_load_dwordx4 v3, s[24:27], s43 offen offset:1024 nt lds
    s_add_u32 s43, s43, 262144
    v_mfma_f32_32x32x16_bf16 v[112:127], v[156:159], v[196:199], v[112:127]
    s_waitcnt vmcnt(6) lgkmcnt(0)
    s_barrier
    v_mfma_f32_32x32x16_bf16 v[64:79], v[160:163], v[200:203], v[64:79]
    ds_read_b64_tr_b16 v[128:129], v14 offset:32768
    ds_read_b64_tr_b16 v[130:131], v14 offset:34816
    ds_read_b64_tr_b16 v[132:133], v15 offset:32768
    ds_read_b64_tr_b16 v[134:135], v15 offset:34816
    s_add_u32 m0, s92, 16384
    s_nop 0
    buffer_load_dwordx4 v2, s[24:27], s43 offen nt lds
    v_mfma_f32_32x32x16_bf16 v[80:95], v[164:167], v[200:203], v[80:95]
    ds_read_b64_tr_b16 v[136:137], v16 offset:32768
    ds_read_b64_tr_b16 v[138:139], v16 offset:34816
    ds_read_b64_tr_b16 v[140:141], v17 offset:32768
    ds_read_b64_tr_b16 v[142:143], v17 offset:34816
    v_mfma_f32_32x32x16_bf16 v[96:111], v[168:171], v[200:203], v[96:111]
    ds_read_b64_tr_b16 v[144:145], v14 offset:40960
    ds_read_b64_tr_b16 v[146:147], v14 offset:43008
    ds_read_b64_tr_b16 v[148:149], v15 offset:40960
    ds_read_b64_tr_b16 v[150:151], v15 offset:43008
    v_mfma_f32_32x32x16_bf16 v[112:127], v[172:175], v[200:203], v[112:127]
    ds_read_b64_tr_b16 v[152:153], v16 offset:40960
    ds_read_b64_tr_b16 v[154:155], v16 offset:43008
    ds_read_b64_tr_b16 v[156:157], v17 offset:40960
    ds_read_b64_tr_b16 v[158:159], v17 offset:43008
    v_mfma_f32_32x32x16_bf16 v[64:79], v[176:179], v[204:207], v[64:79]
    ds_read_b128 v[208:211], v18 offset:16384
    ds_read_b128 v[212:215], v19 offset:16384
    ds_read_b128 v[216:219], v20 offset:16384
    ds_read_b128 v[220:223], v21 offset:16384
    s_add_u32 m0, s92, 16384
    s_nop 0
    buffer_load_dwordx4 v3, s[24:27], s43 offen offset:1024 nt lds
    s_add_u32 s43, s43, 262144
    v_mfma_f32_32x32x16_bf16 v[80:95], v[180:183], v[204:207], v[80:95]
    v_mfma_f32_32x32x16_bf16 v[96:111], v[184:187], v[204:207], v[96:111]
    v_mfma_f32_32x32x16_bf16 v[112:127], v[188:191], v[204:207], v[112:127]
    s_waitcnt vmcnt(6) lgkmcnt(0)
    s_barrier
    v_mfma_f32_32x32x16_bf16 v[64:79], v[128:131], v[208:211], v[64:79]
    ds_read_b64_tr_b16 v[160:161], v14 offset:49152
    ds_read_b64_tr_b16 v[162:163], v14 offset:51200
    ds_read_b64_tr_b16 v[164:165], v15 offset:49152
    ds_read_b64_tr_b16 v[166:167], v15 offset:51200
    s_add_u32 m0, s93, 16384
    s_nop 0
    buffer_load_dwordx4 v4, s[20:23], s44 offen  lds
    v_mfma_f32_32x32x16_bf16 v[80:95], v[132:135], v[208:211], v[80:95]
    ds_read_b64_tr_b16 v[168:169], v16 offset:49152
    ds_read_b64_tr_b16 v[170:171], v16 offset:51200
    ds_read_b64_tr_b16 v[172:173], v17 offset:49152
    ds_read_b64_tr_b16 v[174:175], v17 offset:51200
    v_mfma_f32_32x32x16_bf16 v[96:111], v[136:139], v[208:211], v[96:111]
    ds_read_b64_tr_b16 v[176:177], v14 offset:57344
    ds_read_b64_tr_b16 v[178:179], v14 offset:59392
    ds_read_b64_tr_b16 v[180:181], v15 offset:57344
    ds_read_b64_tr_b16 v[182:183], v15 offset:59392
    s_add_u32 m0, s93, 16384
    s_nop 0
    buffer_load_dwordx4 v5, s[20:23], s44 offen offset:1024  lds
    s_add_u32 s44, s44, 128
    v_mfma_f32_32x32x16_bf16 v[112:127], v[140:143], v[208:211], v[112:127]
    ds_read_b64_tr_b16 v[184:185], v16 offset:57344
    ds_read_b64_tr_b16 v[186:187], v16 offset:59392
    ds_read_b64_tr_b16 v[188:189], v17 offset:57344
    ds_read_b64_tr_b16 v[190:191], v17 offset:59392
    v_mfma_f32_32x32x16_bf16 v[64:79], v[144:147], v[212:215], v[64:79]
    s_add_u32 m0, s92, 32768
    s_nop 0
    buffer_load_dwordx4 v2, s[24:27], s43 offen nt lds
    v_mfma_f32_32x32x16_bf16 v[80:95], v[148:151], v[212:215], v[80:95]
    v_mfma_f32_32x32x16_bf16 v[96:111], v[152:155], v[212:215], v[96:111]
    s_add_u32 m0, s92, 32768
    s_nop 0
    buffer_load_dwordx4 v3, s[24:27], s43 offen offset:1024 nt lds
    s_add_u32 s43, s43, 262144
    v_mfma_f32_32x32x16_bf16 v[112:127], v[156:159], v[212:215], v[112:127]
    s_waitcnt vmcnt(6) lgkmcnt(0)
    s_barrier
    v_mfma_f32_32x32x16_bf16 v[64:79], v[160:163], v[216:219], v[64:79]
    ds_read_b64_tr_b16 v[128:129], v14 offset:0
    ds_read_b64_tr_b16 v[130:131], v14 offset:2048
    ds_read_b64_tr_b16 v[132:133], v15 offset:0
    ds_read_b64_tr_b16 v[134:135], v15 offset:2048
    s_add_u32 m0, s92, 49152
    s_nop 0
    buffer_load_dwordx4 v2, s[24:27], s43 offen nt lds
    v_mfma_f32_32x32x16_bf16 v[80:95], v[164:167], v[216:219], v[80:95]
    ds_read_b64_tr_b16 v[136:137], v16 offset:0
    ds_read_b64_tr_b16 v[138:139], v16 offset:2048
    ds_read_b64_tr_b16 v[140:141], v17 offset:0
    ds_read_b64_tr_b16 v[142:143], v17 offset:2048
    v_mfma_f32_32x32x16_bf16 v[96:111], v[168:171], v[216:219], v[96:111]
    ds_read_b64_tr_b16 v[144:145], v14 offset:8192
    ds_read_b64_tr_b16 v[146:147], v14 offset:10240
    ds_read_b64_tr_b16 v[148:149], v15 offset:8192
    ds_read_b64_tr_b16 v[150:151], v15 offset:10240
    v_mfma_f32_32x32x16_bf16 v[112:127], v[172:175], v[216:219], v[112:127]
    ds_read_b64_tr_b16 v[152:153], v16 offset:8192
    ds_read_b64_tr_b16 v[154:155], v16 offset:10240
    ds_read_b64_tr_b16 v[156:157], v17 offset:8192
    ds_read_b64_tr_b16 v[158:159], v17 offset:10240
    v_mfma_f32_32x32x16_bf16 v[64:79], v[176:179], v[220:223], v[64:79]
    ds_read_b128 v[192:195], v18 offset:0
    ds_read_b128 v[196:199], v19 offset:0
    ds_read_b128 v[200:203], v20 offset:0
    ds_read_b128 v[204:207], v21 offset:0
    s_add_u32 m0, s92, 49152
    s_nop 0
    buffer_load_dwordx4 v3, s[24:27], s43 offen offset:1024 nt lds
    s_add_u32 s43, s43, 262144
    v_mfma_f32_32x32x16_bf16 v[80:95], v[180:183], v[220:223], v[80:95]
    v_mfma_f32_32x32x16_bf16 v[96:111], v[184:187], v[220:223], v[96:111]
    v_mfma_f32_32x32x16_bf16 v[112:127], v[188:191], v[220:223], v[112:127]
    s_add_u32 s46, s46, 1
    s_cmp_lt_u32 s46, 5
    s_cbranch_scc1 L_qp_loop
    s_waitcnt vmcnt(6) lgkmcnt(0)
    s_barrier
    v_mfma_f32_32x32x16_bf16 v[64:79], v[128:131], v[192:195], v[64:79]
    ds_read_b64_tr_b16 v[160:161], v14 offset:16384
    ds_read_b64_tr_b16 v[162:163], v14 offset:18432
    ds_read_b64_tr_b16 v[164:165], v15 offset:16384
    ds_read_b64_tr_b16 v[166:167], v15 offset:18432
    s_add_u32 m0, s93, 0
    s_nop 0
    buffer_load_dwordx4 v4, s[20:23], s44 offen  lds
    v_mfma_f32_32x32x16_bf16 v[80:95], v[132:135], v[192:195], v[80:95]
    ds_read_b64_tr_b16 v[168:169], v16 offset:16384
    ds_read_b64_tr_b16 v[170:171], v16 offset:18432
    ds_read_b64_tr_b16 v[172:173], v17 offset:16384
    ds_read_b64_tr_b16 v[174:175], v17 offset:18432
    s_add_u32 m0, s93, 0
    s_nop 0
    buffer_load_dwordx4 v5, s[20:23], s44 offen offset:1024  lds
    s_add_u32 s44, s44, 128
    v_mfma_f32_32x32x16_bf16 v[96:111], v[136:139], v[192:195], v[96:111]
    ds_read_b64_tr_b16 v[176:177], v14 offset:24576
    ds_read_b64_tr_b16 v[178:179], v14 offset:26624
    ds_read_b64_tr_b16 v[180:181], v15 offset:24576
    ds_read_b64_tr_b16 v[182:183], v15 offset:26624
    v_mfma_f32_32x32x16_bf16 v[112:127], v[140:143], v[192:195], v[112:127]
    ds_read_b64_tr_b16 v[184:185], v16 offset:24576
    ds_read_b64_tr_b16 v[186:187], v16 offset:26624
    ds_read_b64_tr_b16 v[188:189], v17 offset:24576
    ds_read_b64_tr_b16 v[190:191], v17 offset:26624
    s_add_u32 m0, s92, 0
    s_nop 0
    buffer_load_dwordx4 v2, s[24:27], s43 offen nt lds
    v_mfma_f32_32x32x16_bf16 v[64:79], v[144:147], v[196:199], v[64:79]
    s_add_u32 m0, s92, 0
    s_nop 0
    buffer_load_dwordx4 v3, s[24:27], s43 offen offset:1024 nt lds
    s_add_u32 s43, s43, 262144
    v_mfma_f32_32x32x16_bf16 v[80:95], v[148:151], v[196:199], v[80:95]
    v_mfma_f32_32x32x16_bf16 v[96:111], v[152:155], v[196:199], v[96:111]
    s_add_u32 m0, s42, 0
    s_mov_b32 s48, 0
    buffer_load_dwordx4 v6, s[28:31], s48 offen offset:0 nt lds
    v_mfma_f32_32x32x16_bf16 v[112:127], v[156:159], v[196:199], v[112:127]
    s_waitcnt vmcnt(7) lgkmcnt(0)
    s_barrier
    v_mfma_f32_32x32x16_bf16 v[64:79], v[160:163], v[200:203], v[64:79]
    ds_read_b64_tr_b16 v[128:129], v14 offset:32768
    ds_read_b64_tr_b16 v[130:131], v14 offset:34816
    ds_read_b64_tr_b16 v[132:133], v15 offset:32768
    ds_read_b64_tr_b16 v[134:135], v15 offset:34816
    s_add_u32 m0, s92, 16384
    s_nop 0
    buffer_load_dwordx4 v2, s[24:27], s43 offen nt lds
    v_mfma_f32_32x32x16_bf16 v[80:95], v[164:167], v[200:203], v[80:95]
    ds_read_b64_tr_b16 v[136:137], v16 offset:32768
    ds_read_b64_tr_b16 v[138:139], v16 offset:34816
    ds_read_b64_tr_b16 v[140:141], v17 offset:32768
    ds_read_b64_tr_b16 v[142:143], v17 offset:34816
    v_mfma_f32_32x32x16_bf16 v[96:111], v[168:171], v[200:203], v[96:111]
    ds_read_b64_tr_b16 v[144:145], v14 offset:40960
    ds_read_b64_tr_b16 v[146:147], v14 offset:43008
    ds_read_b64_tr_b16 v[148:149], v15 offset:40960
    ds_read_b64_tr_b16 v[150:151], v15 offset:43008
    s_add_u32 m0, s92, 16384
    s_nop 0
    buffer_load_dwordx4 v3, s[24:27], s43 offen offset:1024 nt lds
    s_add_u32 s43, s43, 262144
    v_mfma_f32_32x32x16_bf16 v[112:127], v[172:175], v[200:203], v[112:127]
    ds_read_b64_tr_b16 v[152:153], v16 offset:40960
    ds_read_b64_tr_b16 v[154:155], v16 offset:43008
    ds_read_b64_tr_b16 v[156:157], v17 offset:40960
    ds_read_b64_tr_b16 v[158:159], v17 offset:43008
    v_mfma_f32_32x32x16_bf16 v[64:79], v[176:179], v[204:207], v[64:79]
    ds_read_b128 v[208:211], v18 offset:16384
    ds_read_b128 v[212:215], v19 offset:16384
    ds_read_b128 v[216:219], v20 offset:16384
    ds_read_b128 v[220:223], v21 offset:16384
    v_mfma_f32_32x32x16_bf16 v[80:95], v[180:183], v[204:207], v[80:95]
    s_add_u32 m0, s42, 0
    s_mov_b32 s48, 0
    buffer_load_dwordx4 v7, s[28:31], s48 offen offset:1024 nt lds
    v_mfma_f32_32x32x16_bf16 v[96:111], v[184:187], v[204:207], v[96:111]
    v_mfma_f32_32x32x16_bf16 v[112:127], v[188:191], v[204:207], v[112:127]
    s_waitcnt vmcnt(8) lgkmcnt(0)
    s_barrier
    v_mfma_f32_32x32x16_bf16 v[64:79], v[128:131], v[208:211], v[64:79]
    ds_read_b64_tr_b16 v[160:161], v14 offset:49152
    ds_read_b64_tr_b16 v[162:163], v14 offset:51200
    ds_read_b64_tr_b16 v[164:165], v15 offset:49152
    ds_read_b64_tr_b16 v[166:167], v15 offset:51200
    s_add_u32 m0, s93, 16384
    s_nop 0
    buffer_load_dwordx4 v4, s[20:23], s44 offen  lds
    v_mfma_f32_32x32x16_bf16 v[80:95], v[132:135], v[208:211], v[80:95]
    ds_read_b64_tr_b16 v[168:169], v16 offset:49152
    ds_read_b64_tr_b16 v[170:171], v16 offset:51200
    ds_read_b64_tr_b16 v[172:173], v17 offset:49152
    ds_read_b64_tr_b16 v[174:175], v17 offset:51200
    s_add_u32 m0, s93, 16384
    s_nop 0
    buffer_load_dwordx4 v5, s[20:23], s44 offen offset:1024  lds
    s_add_u32 s44, s44, 128
    v_mfma_f32_32x32x16_bf16 v[96:111], v[136:139], v[208:211], v[96:111]
    ds_read_b64_tr_b16 v[176:177], v14 offset:57344
    ds_read_b64_tr_b16 v[178:179], v14 offset:59392
    ds_read_b64_tr_b16 v[180:181], v15 offset:57344
    ds_read_b64_tr_b16 v[182:183], v15 offset:59392
    v_mfma_f32_32x32x16_bf16 v[112:127], v[140:143], v[208:211], v[112:127]
    ds_read_b64_tr_b16 v[184:185], v16 offset:57344
    ds_read_b64_tr_b16 v[186:187], v16 offset:59392
    ds_read_b64_tr_b16 v[188:189], v17 offset:57344
    ds_read_b64_tr_b16 v[190:191], v17 offset:59392
    s_add_u32 m0, s92, 32768
    s_nop 0
    buffer_load_dwordx4 v2, s[24:27], s43 offen nt lds
    v_mfma_f32_32x32x16_bf16 v[64:79], v[144:147], v[212:215], v[64:79]
    s_add_u32 m0, s92, 32768
    s_nop 0
    buffer_load_dwordx4 v3, s[24:27], s43 offen offset:1024 nt lds
    s_add_u32 s43, s43, 262144
    v_mfma_f32_32x32x16_bf16 v[80:95], v[148:151], v[212:215], v[80:95]
    v_mfma_f32_32x32x16_bf16 v[96:111], v[152:155], v[212:215], v[96:111]
    s_add_u32 m0, s42, 0
    s_mov_b32 s48, 0
    buffer_load_dwordx4 v8, s[28:31], s48 offen offset:2048 nt lds
    v_mfma_f32_32x32x16_bf16 v[112:127], v[156:159], v[212:215], v[112:127]
    s_waitcnt vmcnt(9) lgkmcnt(0)
    s_barrier
    v_mfma_f32_32x32x16_bf16 v[64:79], v[160:163], v[216:219], v[64:79]
    ds_read_b64_tr_b16 v[128:129], v14 offset:0
    ds_read_b64_tr_b16 v[130:131], v14 offset:2048
    ds_read_b64_tr_b16 v[132:133], v15 offset:0
    ds_read_b64_tr_b16 v[134:135], v15 offset:2048
    s_add_u32 m0, s92, 49152
    s_nop 0
    buffer_load_dwordx4 v2, s[24:27], s43 offen nt lds
    v_mfma_f32_32x32x16_bf16 v[80:95], v[164:167], v[216:219], v[80:95]
    ds_read_b64_tr_b16 v[136:137], v16 offset:0
    ds_read_b64_tr_b16 v[138:139], v16 offset:2048
    ds_read_b64_tr_b16 v[140:141], v17 offset:0
    ds_read_b64_tr_b16 v[142:143], v17 offset:2048
    v_mfma_f32_32x32x16_bf16 v[96:111], v[168:171], v[216:219], v[96:111]
    ds_read_b64_tr_b16 v[144:145], v14 offset:8192
    ds_read_b64_tr_b16 v[146:147], v14 offset:10240
    ds_read_b64_tr_b16 v[148:149], v15 offset:8192
    ds_read_b64_tr_b16 v[150:151], v15 offset:10240
    s_add_u32 m0, s92, 49152
    s_nop 0
    buffer_load_dwordx4 v3, s[24:27], s43 offen offset:1024 nt lds
    s_add_u32 s43, s43, 262144
    v_mfma_f32_32x32x16_bf16 v[112:127], v[172:175], v[216:219], v[112:127]
    ds_read_b64_tr_b16 v[152:153], v16 offset:8192
    ds_read_b64_tr_b16 v[154:155], v16 offset:10240
    ds_read_b64_tr_b16 v[156:157], v17 offset:8192
    ds_read_b64_tr_b16 v[158:159], v17 offset:10240
    v_mfma_f32_32x32x16_bf16 v[64:79], v[176:179], v[220:223], v[64:79]
    ds_read_b128 v[192:195], v18 offset:0
    ds_read_b128 v[196:199], v19 offset:0
    ds_read_b128 v[200:203], v20 offset:0
    ds_read_b128 v[204:207], v21 offset:0
    v_mfma_f32_32x32x16_bf16 v[80:95], v[180:183], v[220:223], v[80:95]
    s_add_u32 m0, s42, 0
    s_mov_b32 s48, 0
    buffer_load_dwordx4 v9, s[28:31], s48 offen offset:3072 nt lds
    v_mfma_f32_32x32x16_bf16 v[96:111], v[184:187], v[220:223], v[96:111]
    v_mfma_f32_32x32x16_bf16 v[112:127], v[188:191], v[220:223], v[112:127]
    s_waitcnt vmcnt(9) lgkmcnt(0)
    s_barrier
    v_mfma_f32_32x32x16_bf16 v[64:79], v[128:131], v[192:195], v[64:79]
    ds_read_b64_tr_b16 v[160:161], v14 offset:16384
    ds_read_b64_tr_b16 v[162:163], v14 offset:18432
    ds_read_b64_tr_b16 v[164:165], v15 offset:16384
    ds_read_b64_tr_b16 v[166:167], v15 offset:18432
    s_add_u32 m0, s93, 0
    s_nop 0
    buffer_load_dwordx4 v4, s[20:23], s44 offen  lds
    v_mfma_f32_32x32x16_bf16 v[80:95], v[132:135], v[192:195], v[80:95]
    ds_read_b64_tr_b16 v[168:169], v16 offset:16384
    ds_read_b64_tr_b16 v[170:171], v16 offset:18432
    ds_read_b64_tr_b16 v[172:173], v17 offset:16384
    ds_read_b64_tr_b16 v[174:175], v17 offset:18432
    s_add_u32 m0, s93, 0
    s_nop 0
    buffer_load_dwordx4 v5, s[20:23], s44 offen offset:1024  lds
    s_add_u32 s44, s44, 128
    v_mfma_f32_32x32x16_bf16 v[96:111], v[136:139], v[192:195], v[96:111]
    ds_read_b64_tr_b16 v[176:177], v14 offset:24576
    ds_read_b64_tr_b16 v[178:179], v14 offset:26624
    ds_read_b64_tr_b16 v[180:181], v15 offset:24576
    ds_read_b64_tr_b16 v[182:183], v15 offset:26624
    v_mfma_f32_32x32x16_bf16 v[112:127], v[140:143], v[192:195], v[112:127]
    ds_read_b64_tr_b16 v[184:185], v16 offset:24576
    ds_read_b64_tr_b16 v[186:187], v16 offset:26624
    ds_read_b64_tr_b16 v[188:189], v17 offset:24576
    ds_read_b64_tr_b16 v[190:191], v17 offset:26624
    s_add_u32 m0, s92, 0
    s_nop 0
    buffer_load_dwordx4 v2, s[24:27], s43 offen nt lds
    v_mfma_f32_32x32x16_bf16 v[64:79], v[144:147], v[196:199], v[64:79]
    s_add_u32 m0, s92, 0
    s_nop 0
    buffer_load_dwordx4 v3, s[24:27], s43 offen offset:1024 nt lds
    s_add_u32 s43, s43, 262144
    v_mfma_f32_32x32x16_bf16 v[80:95], v[148:151], v[196:199], v[80:95]
    v_mfma_f32_32x32x16_bf16 v[96:111], v[152:155], v[196:199], v[96:111]
    s_add_u32 m0, s42, 32768
    s_mov_b32 s48, 0
    buffer_load_dwordx4 v10, s[32:35], s48 offen offset:0 nt lds
    v_mfma_f32_32x32x16_bf16 v[112:127], v[156:159], v[196:199], v[112:127]
    s_waitcnt vmcnt(9) lgkmcnt(0)
    s_barrier
    v_mfma_f32_32x32x16_bf16 v[64:79], v[160:163], v[200:203], v[64:79]
    ds_read_b64_tr_b16 v[128:129], v14 offset:32768
    ds_read_b64_tr_b16 v[130:131], v14 offset:34816
    ds_read_b64_tr_b16 v[132:133], v15 offset:32768
    ds_read_b64_tr_b16 v[134:135], v15 offset:34816
    s_add_u32 m0, s92, 16384
    s_nop 0
    buffer_load_dwordx4 v2, s[24:27], s43 offen nt lds
    v_mfma_f32_32x32x16_bf16 v[80:95], v[164:167], v[200:203], v[80:95]
    ds_read_b64_tr_b16 v[136:137], v16 offset:32768
    ds_read_b64_tr_b16 v[138:139], v16 offset:34816
    ds_read_b64_tr_b16 v[140:141], v17 offset:32768
    ds_read_b64_tr_b16 v[142:143], v17 offset:34816
    v_mfma_f32_32x32x16_bf16 v[96:111], v[168:171], v[200:203], v[96:111]
    ds_read_b64_tr_b16 v[144:145], v14 offset:40960
    ds_read_b64_tr_b16 v[146:147], v14 offset:43008
    ds_read_b64_tr_b16 v[148:149], v15 offset:40960
    ds_read_b64_tr_b16 v[150:151], v15 offset:43008
    s_add_u32 m0, s92, 16384
    s_nop 0
    buffer_load_dwordx4 v3, s[24:27], s43 offen offset:1024 nt lds
    s_add_u32 s43, s43, 262144
    v_mfma_f32_32x32x16_bf16 v[112:127], v[172:175], v[200:203], v[112:127]
    ds_read_b64_tr_b16 v[152:153], v16 offset:40960
    ds_read_b64_tr_b16 v[154:155], v16 offset:43008
    ds_read_b64_tr_b16 v[156:157], v17 offset:40960
    ds_read_b64_tr_b16 v[158:159], v17 offset:43008
    v_mfma_f32_32x32x16_bf16 v[64:79], v[176:179], v[204:207], v[64:79]
    ds_read_b128 v[208:211], v18 offset:16384
    ds_read_b128 v[212:215], v19 offset:16384
    ds_read_b128 v[216:219], v20 offset:16384
    ds_read_b128 v[220:223], v21 offset:16384
    v_mfma_f32_32x32x16_bf16 v[80:95], v[180:183], v[204:207], v[80:95]
    s_add_u32 m0, s42, 32768
    s_mov_b32 s48, 0
    buffer_load_dwordx4 v10, s[32:35], s48 offen offset:1024 nt lds
    v_mfma_f32_32x32x16_bf16 v[96:111], v[184:187], v[204:207], v[96:111]
    v_mfma_f32_32x32x16_bf16 v[112:127], v[188:191], v[204:207], v[112:127]
    s_waitcnt vmcnt(9) lgkmcnt(0)
    s_barrier
    v_mfma_f32_32x32x16_bf16 v[64:79], v[128:131], v[208:211], v[64:79]
    ds_read_b64_tr_b16 v[160:161], v14 offset:49152
    ds_read_b64_tr_b16 v[162:163], v14 offset:51200
    ds_read_b64_tr_b16 v[164:165], v15 offset:49152
    ds_read_b64_tr_b16 v[166:167], v15 offset:51200
    s_add_u32 m0, s93, 16384
    s_nop 0
    buffer_load_dwordx4 v4, s[20:23], s44 offen  lds
    v_mfma_f32_32x32x16_bf16 v[80:95], v[132:135], v[208:211], v[80:95]
    ds_read_b64_tr_b16 v[168:169], v16 offset:49152
    ds_read_b64_tr_b16 v[170:171], v16 offset:51200
    ds_read_b64_tr_b16 v[172:173], v17 offset:49152
    ds_read_b64_tr_b16 v[174:175], v17 offset:51200
    s_add_u32 m0, s93, 16384
    s_nop 0
    buffer_load_dwordx4 v5, s[20:23], s44 offen offset:1024  lds
    s_add_u32 s44, s44, 128
    v_mfma_f32_32x32x16_bf16 v[96:111], v[136:139], v[208:211], v[96:111]
    ds_read_b64_tr_b16 v[176:177], v14 offset:57344
    ds_read_b64_tr_b16 v[178:179], v14 offset:59392
    ds_read_b64_tr_b16 v[180:181], v15 offset:57344
    ds_read_b64_tr_b16 v[182:183], v15 offset:59392
    v_mfma_f32_32x32x16_bf16 v[112:127], v[140:143], v[208:211], v[112:127]
    ds_read_b64_tr_b16 v[184:185], v16 offset:57344
    ds_read_b64_tr_b16 v[186:187], v16 offset:59392
    ds_read_b64_tr_b16 v[188:189], v17 offset:57344
    ds_read_b64_tr_b16 v[190:191], v17 offset:59392
    s_add_u32 m0, s92, 32768
    s_nop 0
    buffer_load_dwordx4 v2, s[24:27], s43 offen nt lds
    v_mfma_f32_32x32x16_bf16 v[64:79], v[144:147], v[212:215], v[64:79]
    s_add_u32 m0, s92, 32768
    s_nop 0
    buffer_load_dwordx4 v3, s[24:27], s43 offen offset:1024 nt lds
    s_add_u32 s43, s43, 262144
    v_mfma_f32_32x32x16_bf16 v[80:95], v[148:151], v[212:215], v[80:95]
    v_mfma_f32_32x32x16_bf16 v[96:111], v[152:155], v[212:215], v[96:111]
    s_add_u32 m0, s42, 32768
    s_mov_b32 s48, 0
    buffer_load_dwordx4 v10, s[32:35], s48 offen offset:2048 nt lds
    v_mfma_f32_32x32x16_bf16 v[112:127], v[156:159], v[212:215], v[112:127]
    s_waitcnt vmcnt(9) lgkmcnt(0)
    s_barrier
    v_mfma_f32_32x32x16_bf16 v[64:79], v[160:163], v[216:219], v[64:79]
    ds_read_b64_tr_b16 v[128:129], v14 offset:0
    ds_read_b64_tr_b16 v[130:131], v14 offset:2048
    ds_read_b64_tr_b16 v[132:133], v15 offset:0
    ds_read_b64_tr_b16 v[134:135], v15 offset:2048
    s_add_u32 m0, s92, 49152
    s_nop 0
    buffer_load_dwordx4 v2, s[24:27], s43 offen nt lds
    v_mfma_f32_32x32x16_bf16 v[80:95], v[164:167], v[216:219], v[80:95]
    ds_read_b64_tr_b16 v[136:137], v16 offset:0
    ds_read_b64_tr_b16 v[138:139], v16 offset:2048
    ds_read_b64_tr_b16 v[140:141], v17 offset:0
    ds_read_b64_tr_b16 v[142:143], v17 offset:2048
    v_mfma_f32_32x32x16_bf16 v[96:111], v[168:171], v[216:219], v[96:111]
    ds_read_b64_tr_b16 v[144:145], v14 offset:8192
    ds_read_b64_tr_b16 v[146:147], v14 offset:10240
    ds_read_b64_tr_b16 v[148:149], v15 offset:8192
    ds_read_b64_tr_b16 v[150:151], v15 offset:10240
    s_add_u32 m0, s92, 49152
    s_nop 0
    buffer_load_dwordx4 v3, s[24:27], s43 offen offset:1024 nt lds
    s_add_u32 s43, s43, 262144
    v_mfma_f32_32x32x16_bf16 v[112:127], v[172:175], v[216:219], v[112:127]
    ds_read_b64_tr_b16 v[152:153], v16 offset:8192
    ds_read_b64_tr_b16 v[154:155], v16 offset:10240
    ds_read_b64_tr_b16 v[156:157], v17 offset:8192
    ds_read_b64_tr_b16 v[158:159], v17 offset:10240
    v_mfma_f32_32x32x16_bf16 v[64:79], v[176:179], v[220:223], v[64:79]
    ds_read_b128 v[192:195], v18 offset:0
    ds_read_b128 v[196:199], v19 offset:0
    ds_read_b128 v[200:203], v20 offset:0
    ds_read_b128 v[204:207], v21 offset:0
    v_mfma_f32_32x32x16_bf16 v[80:95], v[180:183], v[220:223], v[80:95]
    s_add_u32 m0, s42, 32768
    s_mov_b32 s48, 0
    buffer_load_dwordx4 v10, s[32:35], s48 offen offset:3072 nt lds
    v_mfma_f32_32x32x16_bf16 v[96:111], v[184:187], v[220:223], v[96:111]
    v_mfma_f32_32x32x16_bf16 v[112:127], v[188:191], v[220:223], v[112:127]
    s_waitcnt vmcnt(9) lgkmcnt(0)
    s_barrier
    v_mfma_f32_32x32x16_bf16 v[64:79], v[128:131], v[192:195], v[64:79]
    ds_read_b64_tr_b16 v[160:161], v14 offset:16384
    ds_read_b64_tr_b16 v[162:163], v14 offset:18432
    ds_read_b64_tr_b16 v[164:165], v15 offset:16384
    ds_read_b64_tr_b16 v[166:167], v15 offset:18432
    v_mfma_f32_32x32x16_bf16 v[80:95], v[132:135], v[192:195], v[80:95]
    ds_read_b64_tr_b16 v[168:169], v16 offset:16384
    ds_read_b64_tr_b16 v[170:171], v16 offset:18432
    ds_read_b64_tr_b16 v[172:173], v17 offset:16384
    ds_read_b64_tr_b16 v[174:175], v17 offset:18432
    v_mfma_f32_32x32x16_bf16 v[96:111], v[136:139], v[192:195], v[96:111]
    ds_read_b64_tr_b16 v[176:177], v14 offset:24576
    ds_read_b64_tr_b16 v[178:179], v14 offset:26624
    ds_read_b64_tr_b16 v[180:181], v15 offset:24576
    ds_read_b64_tr_b16 v[182:183], v15 offset:26624
    v_mfma_f32_32x32x16_bf16 v[112:127], v[140:143], v[192:195], v[112:127]
    ds_read_b64_tr_b16 v[184:185], v16 offset:24576
    ds_read_b64_tr_b16 v[186:187], v16 offset:26624
    ds_read_b64_tr_b16 v[188:189], v17 offset:24576
    ds_read_b64_tr_b16 v[190:191], v17 offset:26624
    v_mfma_f32_32x32x16_bf16 v[64:79], v[144:147], v[196:199], v[64:79]
    v_mfma_f32_32x32x16_bf16 v[80:95], v[148:151], v[196:199], v[80:95]
    v_mfma_f32_32x32x16_bf16 v[96:111], v[152:155], v[196:199], v[96:111]
    v_mfma_f32_32x32x16_bf16 v[112:127], v[156:159], v[196:199], v[112:127]
    s_waitcnt vmcnt(4) lgkmcnt(0)
    s_barrier
    v_mfma_f32_32x32x16_bf16 v[64:79], v[160:163], v[200:203], v[64:79]
    ds_read_b64_tr_b16 v[128:129], v14 offset:32768
    ds_read_b64_tr_b16 v[130:131], v14 offset:34816
    ds_read_b64_tr_b16 v[132:133], v15 offset:32768
    ds_read_b64_tr_b16 v[134:135], v15 offset:34816
    s_add_u32 m0, s42, 65536
    s_mov_b32 s48, 16384
    buffer_load_dwordx4 v6, s[28:31], s48 offen offset:0 nt lds
    v_mfma_f32_32x32x16_bf16 v[80:95], v[164:167], v[200:203], v[80:95]
    ds_read_b64_tr_b16 v[136:137], v16 offset:32768
    ds_read_b64_tr_b16 v[138:139], v16 offset:34816
    ds_read_b64_tr_b16 v[140:141], v17 offset:32768
    ds_read_b64_tr_b16 v[142:143], v17 offset:34816
    v_mfma_f32_32x32x16_bf16 v[96:111], v[168:171], v[200:203], v[96:111]
    ds_read_b64_tr_b16 v[144:145], v14 offset:40960
    ds_read_b64_tr_b16 v[146:147], v14 offset:43008
    ds_read_b64_tr_b16 v[148:149], v15 offset:40960
    ds_read_b64_tr_b16 v[150:151], v15 offset:43008
    s_add_u32 m0, s42, 65536
    s_mov_b32 s48, 16384
    buffer_load_dwordx4 v7, s[28:31], s48 offen offset:1024 nt lds
    v_mfma_f32_32x32x16_bf16 v[112:127], v[172:175], v[200:203], v[112:127]
    ds_read_b64_tr_b16 v[152:153], v16 offset:40960
    ds_read_b64_tr_b16 v[154:155], v16 offset:43008
    ds_read_b64_tr_b16 v[156:157], v17 offset:40960
    ds_read_b64_tr_b16 v[158:159], v17 offset:43008
    v_mfma_f32_32x32x16_bf16 v[64:79], v[176:179], v[204:207], v[64:79]
    ds_read_b128 v[208:211], v18 offset:16384
    ds_read_b128 v[212:215], v19 offset:16384
    ds_read_b128 v[216:219], v20 offset:16384
    ds_read_b128 v[220:223], v21 offset:16384
    s_add_u32 m0, s42, 65536
    s_mov_b32 s48, 16384
    buffer_load_dwordx4 v8, s[28:31], s48 offen offset:2048 nt lds
    v_mfma_f32_32x32x16_bf16 v[80:95], v[180:183], v[204:207], v[80:95]
    v_mfma_f32_32x32x16_bf16 v[96:111], v[184:187], v[204:207], v[96:111]
    s_add_u32 m0, s42, 65536
    s_mov_b32 s48, 16384
    buffer_load_dwordx4 v9, s[28:31], s48 offen offset:3072 nt lds
    v_mfma_f32_32x32x16_bf16 v[112:127], v[188:191], v[204:207], v[112:127]
    s_waitcnt vmcnt(5) lgkmcnt(0)
    s_barrier
    v_mfma_f32_32x32x16_bf16 v[64:79], v[128:131], v[208:211], v[64:79]
    ds_read_b64_tr_b16 v[160:161], v14 offset:49152
    ds_read_b64_tr_b16 v[162:163], v14 offset:51200
    ds_read_b64_tr_b16 v[164:165], v15 offset:49152
    ds_read_b64_tr_b16 v[166:167], v15 offset:51200
    v_mfma_f32_32x32x16_bf16 v[80:95], v[132:135], v[208:211], v[80:95]
    ds_read_b64_tr_b16 v[168:169], v16 offset:49152
    ds_read_b64_tr_b16 v[170:171], v16 offset:51200
    ds_read_b64_tr_b16 v[172:173], v17 offset:49152
    ds_read_b64_tr_b16 v[174:175], v17 offset:51200
    v_mfma_f32_32x32x16_bf16 v[96:111], v[136:139], v[208:211], v[96:111]
    ds_read_b64_tr_b16 v[176:177], v14 offset:57344
    ds_read_b64_tr_b16 v[178:179], v14 offset:59392
    ds_read_b64_tr_b16 v[180:181], v15 offset:57344
    ds_read_b64_tr_b16 v[182:183], v15 offset:59392
    v_mfma_f32_32x32x16_bf16 v[112:127], v[140:143], v[208:211], v[112:127]
    ds_read_b64_tr_b16 v[184:185], v16 offset:57344
    ds_read_b64_tr_b16 v[186:187], v16 offset:59392
    ds_read_b64_tr_b16 v[188:189], v17 offset:57344
    ds_read_b64_tr_b16 v[190:191], v17 offset:59392
    v_mfma_f32_32x32x16_bf16 v[64:79], v[144:147], v[212:215], v[64:79]
    v_mfma_f32_32x32x16_bf16 v[80:95], v[148:151], v[212:215], v[80:95]
    v_mfma_f32_32x32x16_bf16 v[96:111], v[152:155], v[212:215], v[96:111]
    v_mfma_f32_32x32x16_bf16 v[112:127], v[156:159], v[212:215], v[112:127]
    s_waitcnt lgkmcnt(0)
    s_barrier
    v_mfma_f32_32x32x16_bf16 v[64:79], v[160:163], v[216:219], v[64:79]
    s_add_u32 m0, s42, 98304
    s_mov_b32 s48, 16384
    buffer_load_dwordx4 v10, s[32:35], s48 offen offset:0 nt lds
    v_mfma_f32_32x32x16_bf16 v[80:95], v[164:167], v[216:219], v[80:95]
    v_mfma_f32_32x32x16_bf16 v[96:111], v[168:171], v[216:219], v[96:111]
    s_add_u32 m0, s42, 98304
    s_mov_b32 s48, 16384
    buffer_load_dwordx4 v10, s[32:35], s48 offen offset:1024 nt lds
    v_mfma_f32_32x32x16_bf16 v[112:127], v[172:175], v[216:219], v[112:127]
    v_mfma_f32_32x32x16_bf16 v[64:79], v[176:179], v[220:223], v[64:79]
    s_add_u32 m0, s42, 98304
    s_mov_b32 s48, 16384
    buffer_load_dwordx4 v10, s[32:35], s48 offen offset:2048 nt lds
    v_mfma_f32_32x32x16_bf16 v[80:95], v[180:183], v[220:223], v[80:95]
    v_mfma_f32_32x32x16_bf16 v[96:111], v[184:187], v[220:223], v[96:111]
    s_add_u32 m0, s42, 98304
    s_mov_b32 s48, 16384
    buffer_load_dwordx4 v10, s[32:35], s48 offen offset:3072 nt lds
    v_mfma_f32_32x32x16_bf16 v[112:127], v[188:191], v[220:223], v[112:127]
    s_nop 7
    s_nop 3
    v_mul_f32 v64, s47, v64
    v_mul_f32 v65, s47, v65
    v_mul_f32 v66, s47, v66
    v_mul_f32 v67, s47, v67
    v_mul_f32 v68, s47, v68
    v_mul_f32 v69, s47, v69
    v_mul_f32 v70, s47, v70
    v_mul_f32 v71, s47, v71
    v_cvt_pk_bf16_f32 v192, v64, v65
    v_cvt_pk_bf16_f32 v193, v66, v67
    v_cvt_pk_bf16_f32 v194, v68, v69
    v_cvt_pk_bf16_f32 v195, v70, v71
    v_mul_f32 v72, s47, v72
    v_mul_f32 v73, s47, v73
    v_mul_f32 v74, s47, v74
    v_mul_f32 v75, s47, v75
    v_mul_f32 v76, s47, v76
    v_mul_f32 v77, s47, v77
    v_mul_f32 v78, s47, v78
    v_mul_f32 v79, s47, v79
    v_cvt_pk_bf16_f32 v196, v72, v73
    v_cvt_pk_bf16_f32 v197, v74, v75
    v_cvt_pk_bf16_f32 v198, v76, v77
    v_cvt_pk_bf16_f32 v199, v78, v79
    v_mul_f32 v80, s47, v80
    v_mul_f32 v81, s47, v81
    v_mul_f32 v82, s47, v82
    v_mul_f32 v83, s47, v83
    v_mul_f32 v84, s47, v84
    v_mul_f32 v85, s47, v85
    v_mul_f32 v86, s47, v86
    v_mul_f32 v87, s47, v87
    v_cvt_pk_bf16_f32 v200, v80, v81
    v_cvt_pk_bf16_f32 v201, v82, v83
    v_cvt_pk_bf16_f32 v202, v84, v85
    v_cvt_pk_bf16_f32 v203, v86, v87
    v_mul_f32 v88, s47, v88
    v_mul_f32 v89, s47, v89
    v_mul_f32 v90, s47, v90
    v_mul_f32 v91, s47, v91
    v_mul_f32 v92, s47, v92
    v_mul_f32 v93, s47, v93
    v_mul_f32 v94, s47, v94
    v_mul_f32 v95, s47, v95
    v_cvt_pk_bf16_f32 v204, v88, v89
    v_cvt_pk_bf16_f32 v205, v90, v91
    v_cvt_pk_bf16_f32 v206, v92, v93
    v_cvt_pk_bf16_f32 v207, v94, v95
    v_mul_f32 v96, s47, v96
    v_mul_f32 v97, s47, v97
    v_mul_f32 v98, s47, v98
    v_mul_f32 v99, s47, v99
    v_mul_f32 v100, s47, v100
    v_mul_f32 v101, s47, v101
    v_mul_f32 v102, s47, v102
    v_mul_f32 v103, s47, v103
    v_cvt_pk_bf16_f32 v208, v96, v97
    v_cvt_pk_bf16_f32 v209, v98, v99
    v_cvt_pk_bf16_f32 v210, v100, v101
    v_cvt_pk_bf16_f32 v211, v102, v103
    v_mul_f32 v104, s47, v104
    v_mul_f32 v105, s47, v105
    v_mul_f32 v106, s47, v106
    v_mul_f32 v107, s47, v107
    v_mul_f32 v108, s47, v108
    v_mul_f32 v109, s47, v109
    v_mul_f32 v110, s47, v110
    v_mul_f32 v111, s47, v111
    v_cvt_pk_bf16_f32 v212, v104, v105
    v_cvt_pk_bf16_f32 v213, v106, v107
    v_cvt_pk_bf16_f32 v214, v108, v109
    v_cvt_pk_bf16_f32 v215, v110, v111
    v_mul_f32 v112, s47, v112
    v_mul_f32 v113, s47, v113
    v_mul_f32 v114, s47, v114
    v_mul_f32 v115, s47, v115
    v_mul_f32 v116, s47, v116
    v_mul_f32 v117, s47, v117
    v_mul_f32 v118, s47, v118
    v_mul_f32 v119, s47, v119
    v_cvt_pk_bf16_f32 v216, v112, v113
    v_cvt_pk_bf16_f32 v217, v114, v115
    v_cvt_pk_bf16_f32 v218, v116, v117
    v_cvt_pk_bf16_f32 v219, v118, v119
    v_mul_f32 v120, s47, v120
    v_mul_f32 v121, s47, v121
    v_mul_f32 v122, s47, v122
    v_mul_f32 v123, s47, v123
    v_mul_f32 v124, s47, v124
    v_mul_f32 v125, s47, v125
    v_mul_f32 v126, s47, v126
    v_mul_f32 v127, s47, v127
    v_cvt_pk_bf16_f32 v220, v120, v121
    v_cvt_pk_bf16_f32 v221, v122, v123
    v_cvt_pk_bf16_f32 v222, v124, v125
    v_cvt_pk_bf16_f32 v223, v126, v127
    v_mov_b32 v64, 0
    v_mov_b32 v65, 0
    v_mov_b32 v66, 0
    v_mov_b32 v67, 0
    v_mov_b32 v68, 0
    v_mov_b32 v69, 0
    v_mov_b32 v70, 0
    v_mov_b32 v71, 0
    v_mov_b32 v72, 0
    v_mov_b32 v73, 0
    v_mov_b32 v74, 0
    v_mov_b32 v75, 0
    v_mov_b32 v76, 0
    v_mov_b32 v77, 0
    v_mov_b32 v78, 0
    v_mov_b32 v79, 0
    v_mov_b32 v80, 0
    v_mov_b32 v81, 0
    v_mov_b32 v82, 0
    v_mov_b32 v83, 0
    v_mov_b32 v84, 0
    v_mov_b32 v85, 0
    v_mov_b32 v86, 0
    v_mov_b32 v87, 0
    v_mov_b32 v88, 0
    v_mov_b32 v89, 0
    v_mov_b32 v90, 0
    v_mov_b32 v91, 0
    v_mov_b32 v92, 0
    v_mov_b32 v93, 0
    v_mov_b32 v94, 0
    v_mov_b32 v95, 0
    v_mov_b32 v96, 0
    v_mov_b32 v97, 0
    v_mov_b32 v98, 0
    v_mov_b32 v99, 0
    v_mov_b32 v100, 0
    v_mov_b32 v101, 0
    v_mov_b32 v102, 0
    v_mov_b32 v103, 0
    v_mov_b32 v104, 0
    v_mov_b32 v105, 0
    v_mov_b32 v106, 0
    v_mov_b32 v107, 0
    v_mov_b32 v108, 0
    v_mov_b32 v109, 0
    v_mov_b32 v110, 0
    v_mov_b32 v111, 0
    v_mov_b32 v112, 0
    v_mov_b32 v113, 0
    v_mov_b32 v114, 0
    v_mov_b32 v115, 0
    v_mov_b32 v116, 0
    v_mov_b32 v117, 0
    v_mov_b32 v118, 0
    v_mov_b32 v119, 0
    v_mov_b32 v120, 0
    v_mov_b32 v121, 0
    v_mov_b32 v122, 0
    v_mov_b32 v123, 0
    v_mov_b32 v124, 0
    v_mov_b32 v125, 0
    v_mov_b32 v126, 0
    v_mov_b32 v127, 0
    v_mov_b32 v32, 0
    v_mov_b32 v33, 0
    v_mov_b32 v34, 0
    v_mov_b32 v35, 0
    v_mov_b32 v36, 0
    v_mov_b32 v37, 0
    v_mov_b32 v38, 0
    v_mov_b32 v39, 0
    v_mov_b32 v40, 0
    v_mov_b32 v41, 0
    v_mov_b32 v42, 0
    v_mov_b32 v43, 0
    v_mov_b32 v44, 0
    v_mov_b32 v45, 0
    v_mov_b32 v46, 0
    v_mov_b32 v47, 0
    v_mov_b32 v28, 0
    v_mov_b32 v29, 0
    s_mov_b32 s97, 1
    s_waitcnt vmcnt(12)
    s_barrier
    v_add_u32 v14, s40, v11
    v_xor_b32 v15, 32, v14
    v_xor_b32 v16, 64, v14
    v_xor_b32 v17, 96, v14
    v_xor_b32 v18, 128, v14
    v_xor_b32 v19, 160, v14
    v_xor_b32 v20, 192, v14
    v_xor_b32 v21, 224, v14
    s_add_u32 s40, s40, 32768
    s_cmp_ge_u32 s40, 163840
    s_cselect_b32 s40, 0, s40
    ds_read_b128 v[128:131], v14 offset:0
    ds_read_b128 v[132:135], v15 offset:0
    ds_read_b128 v[136:139], v16 offset:0
    ds_read_b128 v[140:143], v17 offset:0
    ds_read_b128 v[144:147], v18 offset:0
    ds_read_b128 v[148:151], v19 offset:0
    ds_read_b128 v[152:155], v20 offset:0
    ds_read_b128 v[156:159], v21 offset:0
    s_waitcnt lgkmcnt(0)
    v_mfma_f32_32x32x16_bf16 v[224:239], v[128:131], v[192:195], v[32:47]
    v_mfma_f32_32x32x16_bf16 v[224:239], v[132:135], v[196:199], v[224:239]
    v_mfma_f32_32x32x16_bf16 v[224:239], v[136:139], v[200:203], v[224:239]
    v_mfma_f32_32x32x16_bf16 v[224:239], v[140:143], v[204:207], v[224:239]
    v_mfma_f32_32x32x16_bf16 v[224:239], v[144:147], v[208:211], v[224:239]
    v_mfma_f32_32x32x16_bf16 v[224:239], v[148:151], v[212:215], v[224:239]
    v_mfma_f32_32x32x16_bf16 v[224:239], v[152:155], v[216:219], v[224:239]
    v_mfma_f32_32x32x16_bf16 v[224:239], v[156:159], v[220:223], v[224:239]
    ds_read_b128 v[128:131], v14 offset:8192
    ds_read_b128 v[132:135], v15 offset:8192
    ds_read_b128 v[136:139], v16 offset:8192
    ds_read_b128 v[140:143], v17 offset:8192
    ds_read_b128 v[144:147], v18 offset:8192
    ds_read_b128 v[148:151], v19 offset:8192
    ds_read_b128 v[152:155], v20 offset:8192
    ds_read_b128 v[156:159], v21 offset:8192
    s_nop 7
    s_nop 3
    v_max3_f32 v30, v224, v225, v226
    v_max3_f32 v31, v227, v228, v229
    v_max3_f32 v30, v30, v230, v231
    v_max3_f32 v31, v31, v232, v233
    v_max3_f32 v30, v30, v234, v235
    v_max3_f32 v31, v31, v236, v237
    v_max3_f32 v30, v30, v238, v239
    v_max_f32 v30, v30, v31
    s_branch L_rare1
L_back1:
    v_exp_f32 v224, v224
    v_exp_f32 v225, v225
    v_exp_f32 v226, v226
    v_exp_f32 v227, v227
    v_exp_f32 v228, v228
    v_exp_f32 v229, v229
    v_exp_f32 v230, v230
    v_exp_f32 v231, v231
    s_mov_b32 s46, 0
L_at_loop:
    s_waitcnt vmcnt(8) lgkmcnt(0)
    s_barrier
    v_add_u32 v22, s40, v12
    v_xor_b32 v23, 64, v22
    v_xor_b32 v24, 128, v22
    v_xor_b32 v25, 192, v22
    s_add_u32 s40, s40, 32768
    s_cmp_ge_u32 s40, 163840
    s_cselect_b32 s40, 0, s40
    v_mfma_f32_32x32x16_bf16 v[240:255], v[128:131], v[192:195], v[32:47]
    ds_read_b64_tr_b16 v[160:161], v22 offset:0
    ds_read_b64_tr_b16 v[162:163], v22 offset:2048
    ds_read_b64_tr_b16 v[164:165], v23 offset:0
    ds_read_b64_tr_b16 v[166:167], v23 offset:2048
    v_exp_f32 v232, v232
    v_exp_f32 v233, v233
    v_exp_f32 v234, v234
    v_mfma_f32_32x32x16_bf16 v[240:255], v[132:135], v[196:199], v[240:255]
    ds_read_b64_tr_b16 v[168:169], v24 offset:0
    ds_read_b64_tr_b16 v[170:171], v24 offset:2048
    ds_read_b64_tr_b16 v[172:173], v25 offset:0
    ds_read_b64_tr_b16 v[174:175], v25 offset:2048
    v_exp_f32 v235, v235
    v_exp_f32 v236, v236
    v_exp_f32 v237, v237
    s_add_u32 m0, s41, s42
    s_nop 0
    buffer_load_dwordx4 v6, s[28:31], s45 offen offset:0 nt lds
    v_mfma_f32_32x32x16_bf16 v[240:255], v[136:139], v[200:203], v[240:255]
    ds_read_b64_tr_b16 v[176:177], v22 offset:4096
    ds_read_b64_tr_b16 v[178:179], v22 offset:6144
    ds_read_b64_tr_b16 v[180:181], v23 offset:4096
    ds_read_b64_tr_b16 v[182:183], v23 offset:6144
    v_exp_f32 v238, v238
    v_exp_f32 v239, v239
    v_cvt_pk_bf16_f32 v48, v224, v225
    v_mfma_f32_32x32x16_bf16 v[240:255], v[140:143], v[204:207], v[240:255]
    ds_read_b64_tr_b16 v[184:185], v24 offset:4096
    ds_read_b64_tr_b16 v[186:187], v24 offset:6144
    ds_read_b64_tr_b16 v[188:189], v25 offset:4096
    ds_read_b64_tr_b16 v[190:191], v25 offset:6144
    v_cvt_pk_bf16_f32 v49, v226, v227
    v_cvt_pk_bf16_f32 v50, v228, v229
    v_cvt_pk_bf16_f32 v51, v230, v231
    s_add_u32 m0, s41, s42
    s_nop 0
    buffer_load_dwordx4 v7, s[28:31], s45 offen offset:1024 nt lds
    v_mfma_f32_32x32x16_bf16 v[240:255], v[144:147], v[208:211], v[240:255]
    v_cvt_pk_bf16_f32 v52, v232, v233
    v_cvt_pk_bf16_f32 v53, v234, v235
    v_cvt_pk_bf16_f32 v54, v236, v237
    v_mfma_f32_32x32x16_bf16 v[240:255], v[148:151], v[212:215], v[240:255]
    v_cvt_pk_bf16_f32 v55, v238, v239
    v_pk_add_f32 v[28:29], v[28:29], v[224:225]
    v_pk_add_f32 v[28:29], v[28:29], v[226:227]
    s_add_u32 m0, s41, s42
    s_nop 0
    buffer_load_dwordx4 v8, s[28:31], s45 offen offset:2048 nt lds
    v_mfma_f32_32x32x16_bf16 v[240:255], v[152:155], v[216:219], v[240:255]
    v_pk_add_f32 v[28:29], v[28:29], v[228:229]
    v_pk_add_f32 v[28:29], v[28:29], v[230:231]
    v_pk_add_f32 v[28:29], v[28:29], v[232:233]
    v_mfma_f32_32x32x16_bf16 v[240:255], v[156:159], v[220:223], v[240:255]
    v_pk_add_f32 v[28:29], v[28:29], v[234:235]
    v_pk_add_f32 v[28:29], v[28:29], v[236:237]
    v_pk_add_f32 v[28:29], v[28:29], v[238:239]
    s_add_u32 m0, s41, s42
    s_nop 0
    buffer_load_dwordx4 v9, s[28:31], s45 offen offset:3072 nt lds
    s_add_u32 s41, s41, 32768
    s_cmp_ge_u32 s41, 163840
    s_cselect_b32 s41, 0, s41
    s_waitcnt vmcnt(8)
    s_barrier
    v_add_u32 v14, s40, v11
    v_xor_b32 v15, 32, v14
    v_xor_b32 v16, 64, v14
    v_xor_b32 v17, 96, v14
    v_xor_b32 v18, 128, v14
    v_xor_b32 v19, 160, v14
    v_xor_b32 v20, 192, v14
    v_xor_b32 v21, 224, v14
    s_add_u32 s40, s40, 32768
    s_cmp_ge_u32 s40, 163840
    s_cselect_b32 s40, 0, s40
    s_waitcnt lgkmcnt(0)
    v_mfma_f32_32x32x16_bf16 v[64:79], v[160:163], v[48:51], v[64:79]
    ds_read_b128 v[128:131], v14 offset:0
    ds_read_b128 v[132:135], v15 offset:0
    s_nop 3
    v_max3_f32 v30, v240, v241, v242
    v_mfma_f32_32x32x16_bf16 v[80:95], v[164:167], v[48:51], v[80:95]
    ds_read_b128 v[136:139], v16 offset:0
    ds_read_b128 v[140:143], v17 offset:0
    v_max3_f32 v31, v243, v244, v245
    v_max3_f32 v30, v30, v246, v247
    s_add_u32 m0, s41, s42
    s_nop 0
    buffer_load_dwordx4 v10, s[32:35], s45 offen offset:0 nt lds
    v_mfma_f32_32x32x16_bf16 v[96:111], v[168:171], v[48:51], v[96:111]
    ds_read_b128 v[144:147], v18 offset:0
    ds_read_b128 v[148:151], v19 offset:0
    v_max3_f32 v31, v31, v248, v249
    v_max3_f32 v30, v30, v250, v251
    v_mfma_f32_32x32x16_bf16 v[112:127], v[172:175], v[48:51], v[112:127]
    ds_read_b128 v[152:155], v20 offset:0
    ds_read_b128 v[156:159], v21 offset:0
    v_max3_f32 v31, v31, v252, v253
    v_max3_f32 v30, v30, v254, v255
    v_max_f32 v30, v30, v31
    s_add_u32 m0, s41, s42
    s_nop 0
    buffer_load_dwordx4 v10, s[32:35], s45 offen offset:1024 nt lds
    v_mfma_f32_32x32x16_bf16 v[64:79], v[176:179], v[52:55], v[64:79]
    v_cmp_lt_f32 vcc, 0x41000000, v30
    s_cbranch_vccnz L_rare2
L_back2:
    v_exp_f32 v240, v240
    v_mfma_f32_32x32x16_bf16 v[80:95], v[180:183], v[52:55], v[80:95]
    v_exp_f32 v241, v241
    v_exp_f32 v242, v242
    s_add_u32 m0, s41, s42
    s_nop 0
    buffer_load_dwordx4 v10, s[32:35], s45 offen offset:2048 nt lds
    v_mfma_f32_32x32x16_bf16 v[96:111], v[184:187], v[52:55], v[96:111]
    v_exp_f32 v243, v243
    v_exp_f32 v244, v244
    v_mfma_f32_32x32x16_bf16 v[112:127], v[188:191], v[52:55], v[112:127]
    v_exp_f32 v245, v245
    v_exp_f32 v246, v246
    v_exp_f32 v247, v247
    s_add_u32 m0, s41, s42
    s_nop 0
    buffer_load_dwordx4 v10, s[32:35], s45 offen offset:3072 nt lds
    s_add_u32 s45, s45, 16384
    s_add_u32 s41, s41, 32768
    s_cmp_ge_u32 s41, 163840
    s_cselect_b32 s41, 0, s41
    s_add_u32 s46, s46, 1
    s_cmp_eq_u32 s46, 8
    s_cbranch_scc1 L_at_tail
    s_waitcnt lgkmcnt(0)
    v_mfma_f32_32x32x16_bf16 v[224:239], v[128:131], v[192:195], v[32:47]
    ds_read_b64_tr_b16 v[160:161], v22 offset:8192
    ds_read_b64_tr_b16 v[162:163], v22 offset:10240
    ds_read_b64_tr_b16 v[164:165], v23 offset:8192
    ds_read_b64_tr_b16 v[166:167], v23 offset:10240
    v_exp_f32 v248, v248
    v_exp_f32 v249, v249
    v_exp_f32 v250, v250
    v_mfma_f32_32x32x16_bf16 v[224:239], v[132:135], v[196:199], v[224:239]
    ds_read_b64_tr_b16 v[168:169], v24 offset:8192
    ds_read_b64_tr_b16 v[170:171], v24 offset:10240
    ds_read_b64_tr_b16 v[172:173], v25 offset:8192
    ds_read_b64_tr_b16 v[174:175], v25 offset:10240
    v_exp_f32 v251, v251
    v_exp_f32 v252, v252
    v_exp_f32 v253, v253
    v_mfma_f32_32x32x16_bf16 v[224:239], v[136:139], v[200:203], v[224:239]
    ds_read_b64_tr_b16 v[176:177], v22 offset:12288
    ds_read_b64_tr_b16 v[178:179], v22 offset:14336
    ds_read_b64_tr_b16 v[180:181], v23 offset:12288
    ds_read_b64_tr_b16 v[182:183], v23 offset:14336
    v_exp_f32 v254, v254
    v_exp_f32 v255, v255
    v_cvt_pk_bf16_f32 v56, v240, v241
    v_mfma_f32_32x32x16_bf16 v[224:239], v[140:143], v[204:207], v[224:239]
    ds_read_b64_tr_b16 v[184:185], v24 offset:12288
    ds_read_b64_tr_b16 v[186:187], v24 offset:14336
    ds_read_b64_tr_b16 v[188:189], v25 offset:12288
    ds_read_b64_tr_b16 v[190:191], v25 offset:14336
    v_cvt_pk_bf16_f32 v57, v242, v243
    v_cvt_pk_bf16_f32 v58, v244, v245
    v_cvt_pk_bf16_f32 v59, v246, v247
    v_mfma_f32_32x32x16_bf16 v[224:239], v[144:147], v[208:211], v[224:239]
    v_cvt_pk_bf16_f32 v60, v248, v249
    v_cvt_pk_bf16_f32 v61, v250, v251
    v_cvt_pk_bf16_f32 v62, v252, v253
    v_mfma_f32_32x32x16_bf16 v[224:239], v[148:151], v[212:215], v[224:239]
    v_cvt_pk_bf16_f32 v63, v254, v255
    v_pk_add_f32 v[28:29], v[28:29], v[240:241]
    v_pk_add_f32 v[28:29], v[28:29], v[242:243]
    v_mfma_f32_32x32x16_bf16 v[224:239], v[152:155], v[216:219], v[224:239]
    v_pk_add_f32 v[28:29], v[28:29], v[244:245]
    v_pk_add_f32 v[28:29], v[28:29], v[246:247]
    v_pk_add_f32 v[28:29], v[28:29], v[248:249]
    v_mfma_f32_32x32x16_bf16 v[224:239], v[156:159], v[220:223], v[224:239]
    v_pk_add_f32 v[28:29], v[28:29], v[250:251]
    v_pk_add_f32 v[28:29], v[28:29], v[252:253]
    v_pk_add_f32 v[28:29], v[28:29], v[254:255]
    s_waitcnt lgkmcnt(0)
    s_nop 1
    v_mfma_f32_32x32x16_bf16 v[64:79], v[160:163], v[56:59], v[64:79]
    ds_read_b128 v[128:131], v14 offset:8192
    ds_read_b128 v[132:135], v15 offset:8192
    s_nop 7
    v_max3_f32 v30, v224, v225, v226
    v_mfma_f32_32x32x16_bf16 v[80:95], v[164:167], v[56:59], v[80:95]
    ds_read_b128 v[136:139], v16 offset:8192
    ds_read_b128 v[140:143], v17 offset:8192
    v_max3_f32 v31, v227, v228, v229
    v_max3_f32 v30, v30, v230, v231
    v_mfma_f32_32x32x16_bf16 v[96:111], v[168:171], v[56:59], v[96:111]
    ds_read_b128 v[144:147], v18 offset:8192
    ds_read_b128 v[148:151], v19 offset:8192
    v_max3_f32 v31, v31, v232, v233
    v_max3_f32 v30, v30, v234, v235
    v_mfma_f32_32x32x16_bf16 v[112:127], v[172:175], v[56:59], v[112:127]
    ds_read_b128 v[152:155], v20 offset:8192
    ds_read_b128 v[156:159], v21 offset:8192
    v_max3_f32 v31, v31, v236, v237
    v_max3_f32 v30, v30, v238, v239
    v_max_f32 v30, v30, v31
    v_mfma_f32_32x32x16_bf16 v[64:79], v[176:179], v[60:63], v[64:79]
    v_cmp_lt_f32 vcc, 0x41000000, v30
    s_cbranch_vccnz L_rare3
L_back3:
    v_exp_f32 v224, v224
    v_mfma_f32_32x32x16_bf16 v[80:95], v[180:183], v[60:63], v[80:95]
    v_exp_f32 v225, v225
    v_exp_f32 v226, v226
    v_mfma_f32_32x32x16_bf16 v[96:111], v[184:187], v[60:63], v[96:111]
    v_exp_f32 v227, v227
    v_exp_f32 v228, v228
    v_mfma_f32_32x32x16_bf16 v[112:127], v[188:191], v[60:63], v[112:127]
    v_exp_f32 v229, v229
    v_exp_f32 v230, v230
    v_exp_f32 v231, v231
    s_branch L_at_loop
L_rare1:
    s_nop 15
    v_mov_b32 v31, v30
    s_nop 1
    v_permlane32_swap_b32 v30, v31
    s_nop 1
    v_max_f32 v30, v30, v31
    v_sub_f32 v32, v32, v30
    v_sub_f32 v33, v33, v30
    v_sub_f32 v34, v34, v30
    v_sub_f32 v35, v35, v30
    v_sub_f32 v36, v36, v30
    v_sub_f32 v37, v37, v30
    v_sub_f32 v38, v38, v30
    v_sub_f32 v39, v39, v30
    v_sub_f32 v40, v40, v30
    v_sub_f32 v41, v41, v30
    v_sub_f32 v42, v42, v30
    v_sub_f32 v43, v43, v30
    v_sub_f32 v44, v44, v30
    v_sub_f32 v45, v45, v30
    v_sub_f32 v46, v46, v30
    v_sub_f32 v47, v47, v30
    v_sub_f32 v224, v224, v30
    v_sub_f32 v225, v225, v30
    v_sub_f32 v226, v226, v30
    v_sub_f32 v227, v227, v30
    v_sub_f32 v228, v228, v30
    v_sub_f32 v229, v229, v30
    v_sub_f32 v230, v230, v30
    v_sub_f32 v231, v231, v30
    v_sub_f32 v232, v232, v30
    v_sub_f32 v233, v233, v30
    v_sub_f32 v234, v234, v30
    v_sub_f32 v235, v235, v30
    v_sub_f32 v236, v236, v30
    v_sub_f32 v237, v237, v30
    v_sub_f32 v238, v238, v30
    v_sub_f32 v239, v239, v30
    s_nop 1
    s_branch L_back1
L_rare2:
    s_nop 15
    v_mov_b32 v31, v30
    s_nop 1
    v_permlane32_swap_b32 v30, v31
    s_nop 1
    v_max_f32 v30, v30, v31
    v_max_f32 v30, 0, v30
    v_sub_f32 v31, 0, v30
    v_exp_f32 v31, v31
    v_sub_f32 v32, v32, v30
    v_sub_f32 v33, v33, v30
    v_sub_f32 v34, v34, v30
    v_sub_f32 v35, v35, v30
    v_sub_f32 v36, v36, v30
    v_sub_f32 v37, v37, v30
    v_sub_f32 v38, v38, v30
    v_sub_f32 v39, v39, v30
    v_sub_f32 v40, v40, v30
    v_sub_f32 v41, v41, v30
    v_sub_f32 v42, v42, v30
    v_sub_f32 v43, v43, v30
    v_sub_f32 v44, v44, v30
    v_sub_f32 v45, v45, v30
    v_sub_f32 v46, v46, v30
    v_sub_f32 v47, v47, v30
    v_sub_f32 v240, v240, v30
    v_sub_f32 v241, v241, v30
    v_sub_f32 v242, v242, v30
    v_sub_f32 v243, v243, v30
    v_sub_f32 v244, v244, v30
    v_sub_f32 v245, v245, v30
    v_sub_f32 v246, v246, v30
    v_sub_f32 v247, v247, v30
    v_sub_f32 v248, v248, v30
    v_sub_f32 v249, v249, v30
    v_sub_f32 v250, v250, v30
    v_sub_f32 v251, v251, v30
    v_sub_f32 v252, v252, v30
    v_sub_f32 v253, v253, v30
    v_sub_f32 v254, v254, v30
    v_sub_f32 v255, v255, v30
    v_mul_f32 v28, v28, v31
    v_mul_f32 v29, v29, v31
    v_mul_f32 v64, v64, v31
    v_mul_f32 v65, v65, v31
    v_mul_f32 v66, v66, v31
    v_mul_f32 v67, v67, v31
    v_mul_f32 v68, v68, v31
    v_mul_f32 v69, v69, v31
    v_mul_f32 v70, v70, v31
    v_mul_f32 v71, v71, v31
    v_mul_f32 v72, v72, v31
    v_mul_f32 v73, v73, v31
    v_mul_f32 v74, v74, v31
    v_mul_f32 v75, v75, v31
    v_mul_f32 v76, v76, v31
    v_mul_f32 v77, v77, v31
    v_mul_f32 v78, v78, v31
    v_mul_f32 v79, v79, v31
    v_mul_f32 v80, v80, v31
    v_mul_f32 v81, v81, v31
    v_mul_f32 v82, v82, v31
    v_mul_f32 v83, v83, v31
    v_mul_f32 v84, v84, v31
    v_mul_f32 v85, v85, v31
    v_mul_f32 v86, v86, v31
    v_mul_f32 v87, v87, v31
    v_mul_f32 v88, v88, v31
    v_mul_f32 v89, v89, v31
    v_mul_f32 v90, v90, v31
    v_mul_f32 v91, v91, v31
    v_mul_f32 v92, v92, v31
    v_mul_f32 v93, v93, v31
    v_mul_f32 v94, v94, v31
    v_mul_f32 v95, v95, v31
    v_mul_f32 v96, v96, v31
    v_mul_f32 v97, v97, v31
    v_mul_f32 v98, v98, v31
    v_mul_f32 v99, v99, v31
    v_mul_f32 v100, v100, v31
    v_mul_f32 v101, v101, v31
    v_mul_f32 v102, v102, v31
    v_mul_f32 v103, v103, v31
    v_mul_f32 v104, v104, v31
    v_mul_f32 v105, v105, v31
    v_mul_f32 v106, v106, v31
    v_mul_f32 v107, v107, v31
    v_mul_f32 v108, v108, v31
    v_mul_f32 v109, v109, v31
    v_mul_f32 v110, v110, v31
    v_mul_f32 v111, v111, v31
    v_mul_f32 v112, v112, v31
    v_mul_f32 v113, v113, v31
    v_mul_f32 v114, v114, v31
    v_mul_f32 v115, v115, v31
    v_mul_f32 v116, v116, v31
    v_mul_f32 v117, v117, v31
    v_mul_f32 v118, v118, v31
    v_mul_f32 v119, v119, v31
    v_mul_f32 v120, v120, v31
    v_mul_f32 v121, v121, v31
    v_mul_f32 v122, v122, v31
    v_mul_f32 v123, v123, v31
    v_mul_f32 v124, v124, v31
    v_mul_f32 v125, v125, v31
    v_mul_f32 v126, v126, v31
    v_mul_f32 v127, v127, v31
    v_mul_f32 v224, v224, v31
    v_mul_f32 v225, v225, v31
    v_mul_f32 v226, v226, v31
    v_mul_f32 v227, v227, v31
    v_mul_f32 v228, v228, v31
    v_mul_f32 v229, v229, v31
    v_mul_f32 v230, v230, v31
    v_mul_f32 v231, v231, v31
    v_mul_f32 v232, v232, v31
    v_mul_f32 v233, v233, v31
    v_mul_f32 v234, v234, v31
    v_mul_f32 v235, v235, v31
    v_mul_f32 v236, v236, v31
    v_mul_f32 v237, v237, v31
    v_mul_f32 v238, v238, v31
    v_mul_f32 v239, v239, v31
    v_cvt_pk_bf16_f32 v48, v224, v225
    v_cvt_pk_bf16_f32 v49, v226, v227
    v_cvt_pk_bf16_f32 v50, v228, v229
    v_cvt_pk_bf16_f32 v51, v230, v231
    v_cvt_pk_bf16_f32 v52, v232, v233
    v_cvt_pk_bf16_f32 v53, v234, v235
    v_cvt_pk_bf16_f32 v54, v236, v237
    v_cvt_pk_bf16_f32 v55, v238, v239
    s_nop 1
    s_branch L_back2
L_rare3:
    s_nop 15
    v_mov_b32 v31, v30
    s_nop 1
    v_permlane32_swap_b32 v30, v31
    s_nop 1
    v_max_f32 v30, v30, v31
    v_max_f32 v30, 0, v30
    v_sub_f32 v31, 0, v30
    v_exp_f32 v31, v31
    v_sub_f32 v32, v32, v30
    v_sub_f32 v33, v33, v30
    v_sub_f32 v34, v34, v30
    v_sub_f32 v35, v35, v30
    v_sub_f32 v36, v36, v30
    v_sub_f32 v37, v37, v30
    v_sub_f32 v38, v38, v30
    v_sub_f32 v39, v39, v30
    v_sub_f32 v40, v40, v30
    v_sub_f32 v41, v41, v30
    v_sub_f32 v42, v42, v30
    v_sub_f32 v43, v43, v30
    v_sub_f32 v44, v44, v30
    v_sub_f32 v45, v45, v30
    v_sub_f32 v46, v46, v30
    v_sub_f32 v47, v47, v30
    v_sub_f32 v224, v224, v30
    v_sub_f32 v225, v225, v30
    v_sub_f32 v226, v226, v30
    v_sub_f32 v227, v227, v30
    v_sub_f32 v228, v228, v30
    v_sub_f32 v229, v229, v30
    v_sub_f32 v230, v230, v30
    v_sub_f32 v231, v231, v30
    v_sub_f32 v232, v232, v30
    v_sub_f32 v233, v233, v30
    v_sub_f32 v234, v234, v30
    v_sub_f32 v235, v235, v30
    v_sub_f32 v236, v236, v30
    v_sub_f32 v237, v237, v30
    v_sub_f32 v238, v238, v30
    v_sub_f32 v239, v239, v30
    v_mul_f32 v28, v28, v31
    v_mul_f32 v29, v29, v31
    v_mul_f32 v64, v64, v31
    v_mul_f32 v65, v65, v31
    v_mul_f32 v66, v66, v31
    v_mul_f32 v67, v67, v31
    v_mul_f32 v68, v68, v31
    v_mul_f32 v69, v69, v31
    v_mul_f32 v70, v70, v31
    v_mul_f32 v71, v71, v31
    v_mul_f32 v72, v72, v31
    v_mul_f32 v73, v73, v31
    v_mul_f32 v74, v74, v31
    v_mul_f32 v75, v75, v31
    v_mul_f32 v76, v76, v31
    v_mul_f32 v77, v77, v31
    v_mul_f32 v78, v78, v31
    v_mul_f32 v79, v79, v31
    v_mul_f32 v80, v80, v31
    v_mul_f32 v81, v81, v31
    v_mul_f32 v82, v82, v31
    v_mul_f32 v83, v83, v31
    v_mul_f32 v84, v84, v31
    v_mul_f32 v85, v85, v31
    v_mul_f32 v86, v86, v31
    v_mul_f32 v87, v87, v31
    v_mul_f32 v88, v88, v31
    v_mul_f32 v89, v89, v31
    v_mul_f32 v90, v90, v31
    v_mul_f32 v91, v91, v31
    v_mul_f32 v92, v92, v31
    v_mul_f32 v93, v93, v31
    v_mul_f32 v94, v94, v31
    v_mul_f32 v95, v95, v31
    v_mul_f32 v96, v96, v31
    v_mul_f32 v97, v97, v31
    v_mul_f32 v98, v98, v31
    v_mul_f32 v99, v99, v31
    v_mul_f32 v100, v100, v31
    v_mul_f32 v101, v101, v31
    v_mul_f32 v102, v102, v31
    v_mul_f32 v103, v103, v31
    v_mul_f32 v104, v104, v31
    v_mul_f32 v105, v105, v31
    v_mul_f32 v106, v106, v31
    v_mul_f32 v107, v107, v31
    v_mul_f32 v108, v108, v31
    v_mul_f32 v109, v109, v31
    v_mul_f32 v110, v110, v31
    v_mul_f32 v111, v111, v31
    v_mul_f32 v112, v112, v31
    v_mul_f32 v113, v113, v31
    v_mul_f32 v114, v114, v31
    v_mul_f32 v115, v115, v31
    v_mul_f32 v116, v116, v31
    v_mul_f32 v117, v117, v31
    v_mul_f32 v118, v118, v31
    v_mul_f32 v119, v119, v31
    v_mul_f32 v120, v120, v31
    v_mul_f32 v121, v121, v31
    v_mul_f32 v122, v122, v31
    v_mul_f32 v123, v123, v31
    v_mul_f32 v124, v124, v31
    v_mul_f32 v125, v125, v31
    v_mul_f32 v126, v126, v31
    v_mul_f32 v127, v127, v31
    v_mul_f32 v240, v240, v31
    v_mul_f32 v241, v241, v31
    v_mul_f32 v242, v242, v31
    v_mul_f32 v243, v243, v31
    v_mul_f32 v244, v244, v31
    v_mul_f32 v245, v245, v31
    v_mul_f32 v246, v246, v31
    v_mul_f32 v247, v247, v31
    v_mul_f32 v248, v248, v31
    v_mul_f32 v249, v249, v31
    v_mul_f32 v250, v250, v31
    v_mul_f32 v251, v251, v31
    v_mul_f32 v252, v252, v31
    v_mul_f32 v253, v253, v31
    v_mul_f32 v254, v254, v31
    v_mul_f32 v255, v255, v31
    v_cvt_pk_bf16_f32 v56, v240, v241
    v_cvt_pk_bf16_f32 v57, v242, v243
    v_cvt_pk_bf16_f32 v58, v244, v245
    v_cvt_pk_bf16_f32 v59, v246, v247
    v_cvt_pk_bf16_f32 v60, v248, v249
    v_cvt_pk_bf16_f32 v61, v250, v251
    v_cvt_pk_bf16_f32 v62, v252, v253
    v_cvt_pk_bf16_f32 v63, v254, v255
    s_nop 1
    s_branch L_back3
L_at_tail:
    s_waitcnt lgkmcnt(0)
    ds_read_b64_tr_b16 v[160:161], v22 offset:8192
    ds_read_b64_tr_b16 v[162:163], v22 offset:10240
    ds_read_b64_tr_b16 v[164:165], v23 offset:8192
    ds_read_b64_tr_b16 v[166:167], v23 offset:10240
    ds_read_b64_tr_b16 v[168:169], v24 offset:8192
    ds_read_b64_tr_b16 v[170:171], v24 offset:10240
    ds_read_b64_tr_b16 v[172:173], v25 offset:8192
    ds_read_b64_tr_b16 v[174:175], v25 offset:10240
    ds_read_b64_tr_b16 v[176:177], v22 offset:12288
    ds_read_b64_tr_b16 v[178:179], v22 offset:14336
    ds_read_b64_tr_b16 v[180:181], v23 offset:12288
    ds_read_b64_tr_b16 v[182:183], v23 offset:14336
    ds_read_b64_tr_b16 v[184:185], v24 offset:12288
    ds_read_b64_tr_b16 v[186:187], v24 offset:14336
    ds_read_b64_tr_b16 v[188:189], v25 offset:12288
    ds_read_b64_tr_b16 v[190:191], v25 offset:14336
    v_exp_f32 v248, v248
    v_exp_f32 v249, v249
    v_exp_f32 v250, v250
    v_exp_f32 v251, v251
    v_exp_f32 v252, v252
    v_exp_f32 v253, v253
    v_exp_f32 v254, v254
    v_exp_f32 v255, v255
    v_cvt_pk_bf16_f32 v56, v240, v241
    v_cvt_pk_bf16_f32 v57, v242, v243
    v_cvt_pk_bf16_f32 v58, v244, v245
    v_cvt_pk_bf16_f32 v59, v246, v247
    v_cvt_pk_bf16_f32 v60, v248, v249
    v_cvt_pk_bf16_f32 v61, v250, v251
    v_cvt_pk_bf16_f32 v62, v252, v253
    v_cvt_pk_bf16_f32 v63, v254, v255
    v_pk_add_f32 v[28:29], v[28:29], v[240:241]
    v_pk_add_f32 v[28:29], v[28:29], v[242:243]
    v_pk_add_f32 v[28:29], v[28:29], v[244:245]
    v_pk_add_f32 v[28:29], v[28:29], v[246:247]
    v_pk_add_f32 v[28:29], v[28:29], v[248:249]
    v_pk_add_f32 v[28:29], v[28:29], v[250:251]
    v_pk_add_f32 v[28:29], v[28:29], v[252:253]
    v_pk_add_f32 v[28:29], v[28:29], v[254:255]
    s_waitcnt lgkmcnt(0)
    s_nop 1
    v_mfma_f32_32x32x16_bf16 v[64:79], v[160:163], v[56:59], v[64:79]
    v_mfma_f32_32x32x16_bf16 v[80:95], v[164:167], v[56:59], v[80:95]
    v_mfma_f32_32x32x16_bf16 v[96:111], v[168:171], v[56:59], v[96:111]
    v_mfma_f32_32x32x16_bf16 v[112:127], v[172:175], v[56:59], v[112:127]
    v_mfma_f32_32x32x16_bf16 v[64:79], v[176:179], v[60:63], v[64:79]
    v_mfma_f32_32x32x16_bf16 v[80:95], v[180:183], v[60:63], v[80:95]
    v_mfma_f32_32x32x16_bf16 v[96:111], v[184:187], v[60:63], v[96:111]
    v_mfma_f32_32x32x16_bf16 v[112:127], v[188:191], v[60:63], v[112:127]
    s_nop 7
    s_nop 3
    v_add_f32 v28, v28, v29
    v_mov_b32 v31, v28
    s_nop 1
    v_permlane32_swap_b32 v28, v31
    s_nop 1
    v_add_f32 v28, v28, v31
    v_rcp_f32 v28, v28
    s_nop 0
    s_mov_b32 s49, 7168
    s_mov_b32 s50, 14336
    s_mov_b32 s51, 21504
    v_mul_f32 v64, v64, v28
    v_mul_f32 v65, v65, v28
    v_mul_f32 v66, v66, v28
    v_mul_f32 v67, v67, v28
    v_mul_f32 v68, v68, v28
    v_mul_f32 v69, v69, v28
    v_mul_f32 v70, v70, v28
    v_mul_f32 v71, v71, v28
    v_cvt_pk_bf16_f32 v128, v64, v65
    v_cvt_pk_bf16_f32 v129, v66, v67
    v_cvt_pk_bf16_f32 v130, v68, v69
    v_cvt_pk_bf16_f32 v131, v70, v71
    buffer_store_dwordx4 v[128:131], v13, s[36:39], 0 offen offset:0 sc0 sc1
    v_mul_f32 v72, v72, v28
    v_mul_f32 v73, v73, v28
    v_mul_f32 v74, v74, v28
    v_mul_f32 v75, v75, v28
    v_mul_f32 v76, v76, v28
    v_mul_f32 v77, v77, v28
    v_mul_f32 v78, v78, v28
    v_mul_f32 v79, v79, v28
    v_cvt_pk_bf16_f32 v132, v72, v73
    v_cvt_pk_bf16_f32 v133, v74, v75
    v_cvt_pk_bf16_f32 v134, v76, v77
    v_cvt_pk_bf16_f32 v135, v78, v79
    buffer_store_dwordx4 v[132:135], v13, s[36:39], 0 offen offset:512 sc0 sc1
    v_mul_f32 v80, v80, v28
    v_mul_f32 v81, v81, v28
    v_mul_f32 v82, v82, v28
    v_mul_f32 v83, v83, v28
    v_mul_f32 v84, v84, v28
    v_mul_f32 v85, v85, v28
    v_mul_f32 v86, v86, v28
    v_mul_f32 v87, v87, v28
    v_cvt_pk_bf16_f32 v136, v80, v81
    v_cvt_pk_bf16_f32 v137, v82, v83
    v_cvt_pk_bf16_f32 v138, v84, v85
    v_cvt_pk_bf16_f32 v139, v86, v87
    buffer_store_dwordx4 v[136:139], v13, s[36:39], s49 offen offset:0 sc0 sc1
    v_mul_f32 v88, v88, v28
    v_mul_f32 v89, v89, v28
    v_mul_f32 v90, v90, v28
    v_mul_f32 v91, v91, v28
    v_mul_f32 v92, v92, v28
    v_mul_f32 v93, v93, v28
    v_mul_f32 v94, v94, v28
    v_mul_f32 v95, v95, v28
    v_cvt_pk_bf16_f32 v140, v88, v89
    v_cvt_pk_bf16_f32 v141, v90, v91
    v_cvt_pk_bf16_f32 v142, v92, v93
    v_cvt_pk_bf16_f32 v143, v94, v95
    buffer_store_dwordx4 v[140:143], v13, s[36:39], s49 offen offset:512 sc0 sc1
    v_mul_f32 v96, v96, v28
    v_mul_f32 v97, v97, v28
    v_mul_f32 v98, v98, v28
    v_mul_f32 v99, v99, v28
    v_mul_f32 v100, v100, v28
    v_mul_f32 v101, v101, v28
    v_mul_f32 v102, v102, v28
    v_mul_f32 v103, v103, v28
    v_cvt_pk_bf16_f32 v144, v96, v97
    v_cvt_pk_bf16_f32 v145, v98, v99
    v_cvt_pk_bf16_f32 v146, v100, v101
    v_cvt_pk_bf16_f32 v147, v102, v103
    buffer_store_dwordx4 v[144:147], v13, s[36:39], s50 offen offset:0 sc0 sc1
    v_mul_f32 v104, v104, v28
    v_mul_f32 v105, v105, v28
    v_mul_f32 v106, v106, v28
    v_mul_f32 v107, v107, v28
    v_mul_f32 v108, v108, v28
    v_mul_f32 v109, v109, v28
    v_mul_f32 v110, v110, v28
    v_mul_f32 v111, v111, v28
    v_cvt_pk_bf16_f32 v148, v104, v105
    v_cvt_pk_bf16_f32 v149, v106, v107
    v_cvt_pk_bf16_f32 v150, v108, v109
    v_cvt_pk_bf16_f32 v151, v110, v111
    buffer_store_dwordx4 v[148:151], v13, s[36:39], s50 offen offset:512 sc0 sc1
    v_mul_f32 v112, v112, v28
    v_mul_f32 v113, v113, v28
    v_mul_f32 v114, v114, v28
    v_mul_f32 v115, v115, v28
    v_mul_f32 v116, v116, v28
    v_mul_f32 v117, v117, v28
    v_mul_f32 v118, v118, v28
    v_mul_f32 v119, v119, v28
    v_cvt_pk_bf16_f32 v152, v112, v113
    v_cvt_pk_bf16_f32 v153, v114, v115
    v_cvt_pk_bf16_f32 v154, v116, v117
    v_cvt_pk_bf16_f32 v155, v118, v119
    buffer_store_dwordx4 v[152:155], v13, s[36:39], s51 offen offset:0 sc0 sc1
    v_mul_f32 v120, v120, v28
    v_mul_f32 v121, v121, v28
    v_mul_f32 v122, v122, v28
    v_mul_f32 v123, v123, v28
    v_mul_f32 v124, v124, v28
    v_mul_f32 v125, v125, v28
    v_mul_f32 v126, v126, v28
    v_mul_f32 v127, v127, v28
    v_cvt_pk_bf16_f32 v156, v120, v121
    v_cvt_pk_bf16_f32 v157, v122, v123
    v_cvt_pk_bf16_f32 v158, v124, v125
    v_cvt_pk_bf16_f32 v159, v126, v127
    buffer_store_dwordx4 v[156:159], v13, s[36:39], s51 offen offset:512 sc0 sc1
L_attn_fin:
    s_waitcnt vmcnt(0) lgkmcnt(0)
    s_barrier
    s_load_dwordx2 s[32:33], s[0:1], 88
    s_load_dwordx2 s[14:15], s[0:1], 80
    s_lshl_b32 s9, s6, 3
    s_add_u32 s9, s9, s8
    s_lshl_b32 s9, s9, 2
    s_waitcnt lgkmcnt(0)
    s_mov_b32 s34, 256
    s_mov_b32 s35, 0x00020000
    s_cmp_lg_u32 s3, 0
    s_cbranch_scc1 L_nopub
    v_mov_b32 v2, s9
    v_mov_b32 v3, 1
    s_mov_b64 s[10:11], exec
    s_mov_b64 exec, 1
    buffer_atomic_add v3, v2, s[32:35], 0 offen sc1
    s_mov_b64 exec, s[10:11]
L_nopub:
    s_and_b32 s4, s2, 7
    s_lshr_b32 s5, s2, 3
    s_lshr_b32 s6, s4, 2
    s_bfe_u32 s7, s4, 0x10001
    s_lshl_b32 s7, s7, 2
    s_and_b32 s8, s5, 3
    s_add_u32 s7, s7, s8
    s_and_b32 s8, s4, 1
    s_lshl_b32 s8, s8, 3
    s_lshr_b32 s9, s5, 2
    s_add_u32 s8, s8, s9
    s_mov_b32 s41, 0x7f000000
    v_lshrrev_b32 v12, 4, v1
    v_and_b32 v13, 15, v1
    v_lshlrev_b32 v2, 4, v1
    v_add_u32 v3, 4096, v2
    s_mul_i32 s42, s3, 8192
    v_lshrrev_b32 v20, 3, v1
    v_bfe_u32 v21, v1, 4, 2
    v_lshlrev_b32 v21, 1, v21
    v_and_b32 v22, 7, v1
    v_xor_b32 v21, v21, v22
    v_lshlrev_b32 v21, 4, v21
    v_lshl_add_u32 v4, v20, 11, v21
    v_add_u32 v5, 15360, v4
    v_add_u32 v6, 30720, v4
    v_add_u32 v7, 46080, v4
    v_bfe_u32 v23, v1, 2, 2
    v_and_b32 v24, 3, v1
    v_and_b32 v20, 1, v12
    v_lshlrev_b32 v20, 1, v20
    v_lshrrev_b32 v21, 1, v23
    v_add_u32 v20, v20, v21
    v_lshlrev_b32 v20, 1, v20
    v_lshrrev_b32 v21, 1, v24
    v_xor_b32 v20, v20, v21
    v_lshlrev_b32 v20, 4, v20
    v_and_b32 v21, 1, v24
    v_lshl_or_b32 v20, v21, 3, v20
    v_and_b32 v21, 1, v12
    v_lshl_add_u32 v21, v21, 2, v23
    v_lshrrev_b32 v22, 1, v12
    v_lshl_add_u32 v21, v22, 4, v21
    v_lshl_add_u32 v20, v21, 7, v20
    v_add_u32 v8, s42, v20
    v_xor_b32 v9, 32, v8
    v_xor_b32 v10, 64, v8
    v_xor_b32 v11, 96, v8
    s_lshl_b32 s9, s6, 3
    s_add_u32 s9, s9, s7
    s_lshl_b32 s43, s9, 2
    s_mul_i32 s9, s9, 917504
    s_add_u32 s20, s52, s9
    s_addc_u32 s21, s53, 0
    s_mov_b32 s22, 917504
    s_mov_b32 s23, 0x00020000
    s_lshl_b32 s9, s8, 7
    s_add_u32 s24, s94, s9
    s_addc_u32 s25, s95, 0
    s_sub_u32 s26, 8388608, s9
    s_mov_b32 s27, 0x00020000
    s_mul_i32 s10, s7, 458752
    s_lshl_b32 s11, s6, 11
    s_add_u32 s10, s10, s11
    s_add_u32 s10, s10, s9
    s_add_u32 s28, s14, s10
    s_addc_u32 s29, s15, 0
    s_mov_b32 s30, 454784
    s_mov_b32 s31, 0x00020000
    v_mov_b32 v27, 163824
    v_mov_b32 v28, 1
    s_cmp_lg_u32 s3, 0
    s_cbranch_scc1 L_noinit
    v_mov_b32 v29, 16
    ds_write_b32 v27, v29
L_noinit:
    s_add_u32 s46, s3, 0
    s_lshl_b32 s44, s46, 16
    s_add_u32 m0, s42, 0
    s_nop 0
    buffer_load_dwordx4 v4, s[24:27], s44 offen offset:0 lds
    buffer_load_dwordx4 v5, s[24:27], s44 offen offset:1024 lds
    buffer_load_dwordx4 v6, s[24:27], s44 offen offset:2048 lds
    buffer_load_dwordx4 v7, s[24:27], s44 offen offset:3072 lds
    s_add_u32 s47, s3, 8
    s_lshl_b32 s44, s47, 16
    s_add_u32 m0, s42, 4096
    s_nop 0
    buffer_load_dwordx4 v4, s[24:27], s44 offen offset:0 lds
    buffer_load_dwordx4 v5, s[24:27], s44 offen offset:1024 lds
    buffer_load_dwordx4 v6, s[24:27], s44 offen offset:2048 lds
    buffer_load_dwordx4 v7, s[24:27], s44 offen offset:3072 lds
    v_lshrrev_b32 v25, 3, v1
    v_lshlrev_b32 v25, 11, v25
    v_and_b32 v26, 7, v1
    v_lshl_add_u32 v25, v26, 4, v25
    s_and_b32 s9, s7, 3
    s_lshl_b32 s9, s9, 14
    v_add_u32 v25, s9, v25
    s_add_u32 s9, s3, 16
    s_lshl_b32 s9, s9, 16
    buffer_load_dword v26, v25, s[24:27], s9 offen
    s_add_u32 s9, s9, 524288
    buffer_load_dword v26, v25, s[24:27], s9 offen
    s_add_u32 s9, s9, 524288
    buffer_load_dword v26, v25, s[24:27], s9 offen
    s_add_u32 s9, s9, 524288
    buffer_load_dword v26, v25, s[24:27], s9 offen
    s_add_u32 s9, s9, 524288
    buffer_load_dword v26, v25, s[24:27], s9 offen
    s_add_u32 s9, s9, 524288
    buffer_load_dword v26, v25, s[24:27], s9 offen
    s_add_u32 s9, s9, 524288
    buffer_load_dword v26, v25, s[24:27], s9 offen
    s_add_u32 s9, s9, 524288
    buffer_load_dword v26, v25, s[24:27], s9 offen
    s_add_u32 s9, s9, 524288
    buffer_load_dword v26, v25, s[24:27], s9 offen
    s_add_u32 s9, s9, 524288
    buffer_load_dword v26, v25, s[24:27], s9 offen
    s_add_u32 s9, s9, 524288
    buffer_load_dword v26, v25, s[24:27], s9 offen
    s_add_u32 s9, s9, 524288
    buffer_load_dword v26, v25, s[24:27], s9 offen
    s_add_u32 s9, s9, 524288
    buffer_load_dword v26, v25, s[24:27], s9 offen
    s_add_u32 s9, s9, 524288
    buffer_load_dword v26, v25, s[24:27], s9 offen
    s_add_u32 s9, s9, 524288
    v_mov_b32 v32, 0
    v_mov_b32 v33, 0
    v_mov_b32 v34, 0
    v_mov_b32 v35, 0
    v_mov_b32 v36, 0
    v_mov_b32 v37, 0
    v_mov_b32 v38, 0
    v_mov_b32 v39, 0
    v_mov_b32 v40, 0
    v_mov_b32 v41, 0
    v_mov_b32 v42, 0
    v_mov_b32 v43, 0
    v_mov_b32 v44, 0
    v_mov_b32 v45, 0
    v_mov_b32 v46, 0
    v_mov_b32 v47, 0
    v_mov_b32 v48, 0
    v_mov_b32 v49, 0
    v_mov_b32 v50, 0
    v_mov_b32 v51, 0
    v_mov_b32 v52, 0
    v_mov_b32 v53, 0
    v_mov_b32 v54, 0
    v_mov_b32 v55, 0
    v_mov_b32 v56, 0
    v_mov_b32 v57, 0
    v_mov_b32 v58, 0
    v_mov_b32 v59, 0
    v_mov_b32 v60, 0
    v_mov_b32 v61, 0
    v_mov_b32 v62, 0
    v_mov_b32 v63, 0
    v_mov_b32 v64, 0
    v_mov_b32 v65, 0
    v_mov_b32 v66, 0
    v_mov_b32 v67, 0
    v_mov_b32 v68, 0
    v_mov_b32 v69, 0
    v_mov_b32 v70, 0
    v_mov_b32 v71, 0
    v_mov_b32 v72, 0
    v_mov_b32 v73, 0
    v_mov_b32 v74, 0
    v_mov_b32 v75, 0
    v_mov_b32 v76, 0
    v_mov_b32 v77, 0
    v_mov_b32 v78, 0
    v_mov_b32 v79, 0
    v_mov_b32 v80, 0
    v_mov_b32 v81, 0
    v_mov_b32 v82, 0
    v_mov_b32 v83, 0
    v_mov_b32 v84, 0
    v_mov_b32 v85, 0
    v_mov_b32 v86, 0
    v_mov_b32 v87, 0
    v_mov_b32 v88, 0
    v_mov_b32 v89, 0
    v_mov_b32 v90, 0
    v_mov_b32 v91, 0
    v_mov_b32 v92, 0
    v_mov_b32 v93, 0
    v_mov_b32 v94, 0
    v_mov_b32 v95, 0
    v_mov_b32 v96, 0
    v_mov_b32 v97, 0
    v_mov_b32 v98, 0
    v_mov_b32 v99, 0
    v_mov_b32 v100, 0
    v_mov_b32 v101, 0
    v_mov_b32 v102, 0
    v_mov_b32 v103, 0
    v_mov_b32 v104, 0
    v_mov_b32 v105, 0
    v_mov_b32 v106, 0
    v_mov_b32 v107, 0
    v_mov_b32 v108, 0
    v_mov_b32 v109, 0
    v_mov_b32 v110, 0
    v_mov_b32 v111, 0
    v_mov_b32 v112, 0
    v_mov_b32 v113, 0
    v_mov_b32 v114, 0
    v_mov_b32 v115, 0
    v_mov_b32 v116, 0
    v_mov_b32 v117, 0
    v_mov_b32 v118, 0
    v_mov_b32 v119, 0
    v_mov_b32 v120, 0
    v_mov_b32 v121, 0
    v_mov_b32 v122, 0
    v_mov_b32 v123, 0
    v_mov_b32 v124, 0
    v_mov_b32 v125, 0
    v_mov_b32 v126, 0
    v_mov_b32 v127, 0
    v_mov_b32 v128, 0
    v_mov_b32 v129, 0
    v_mov_b32 v130, 0
    v_mov_b32 v131, 0
    v_mov_b32 v132, 0
    v_mov_b32 v133, 0
    v_mov_b32 v134, 0
    v_mov_b32 v135, 0
    v_mov_b32 v136, 0
    v_mov_b32 v137, 0
    v_mov_b32 v138, 0
    v_mov_b32 v139, 0
    v_mov_b32 v140, 0
    v_mov_b32 v141, 0
    v_mov_b32 v142, 0
    v_mov_b32 v143, 0
    s_cmp_lg_u32 s3, 0
    s_cbranch_scc1 L_nopoll
    v_mov_b32 v20, s43
    s_mov_b32 s45, 0
    s_mov_b64 s[10:11], exec
    s_mov_b64 exec, 1
L_poll:
    v_mov_b32 v21, 0
    buffer_atomic_add v21, v20, s[32:35], 0 offen sc0 sc1
    s_waitcnt vmcnt(0)
    v_readfirstlane_b32 s44, v21
    s_add_u32 s45, s45, 1
    s_cmp_ge_u32 s44, 16
    s_cbranch_scc1 L_pdone
    s_sleep 2
    s_cmp_lt_u32 s45, 200000
    s_cbranch_scc1 L_poll
L_pdone:
    s_mov_b64 exec, s[10:11]
L_nopoll:
    s_waitcnt lgkmcnt(0)
    s_barrier
    s_mul_i32 s44, s46, 7168
    buffer_load_dwordx4 v[144:147], v2, s[20:23], s44 offen offset:0
    buffer_load_dwordx4 v[148:151], v2, s[20:23], s44 offen offset:1024
    buffer_load_dwordx4 v[152:155], v2, s[20:23], s44 offen offset:2048
    buffer_load_dwordx4 v[156:159], v2, s[20:23], s44 offen offset:3072
    buffer_load_dwordx4 v[160:163], v3, s[20:23], s44 offen offset:0
    buffer_load_dwordx4 v[164:167], v3, s[20:23], s44 offen offset:1024
    buffer_load_dwordx4 v[168:171], v3, s[20:23], s44 offen offset:2048
    s_mul_i32 s44, s47, 7168
    buffer_load_dwordx4 v[172:175], v2, s[20:23], s44 offen offset:0
    buffer_load_dwordx4 v[176:179], v2, s[20:23], s44 offen offset:1024
    buffer_load_dwordx4 v[180:183], v2, s[20:23], s44 offen offset:2048
    buffer_load_dwordx4 v[184:187], v2, s[20:23], s44 offen offset:3072
    buffer_load_dwordx4 v[188:191], v3, s[20:23], s44 offen offset:0
    buffer_load_dwordx4 v[192:195], v3, s[20:23], s44 offen offset:1024
    buffer_load_dwordx4 v[196:199], v3, s[20:23], s44 offen offset:2048
    s_mov_b64 exec, 1
    ds_add_rtn_u32 v29, v27, v28
    s_mov_b64 exec, -1
    s_waitcnt vmcnt(14)
    ds_read_b64_tr_b16 v[200:201], v8 offset:0
    ds_read_b64_tr_b16 v[202:203], v8 offset:1024
    ds_read_b64_tr_b16 v[204:205], v9 offset:0
    ds_read_b64_tr_b16 v[206:207], v9 offset:1024
    ds_read_b64_tr_b16 v[208:209], v10 offset:0
    ds_read_b64_tr_b16 v[210:211], v10 offset:1024
    ds_read_b64_tr_b16 v[212:213], v11 offset:0
    ds_read_b64_tr_b16 v[214:215], v11 offset:1024
L_f_loop:
    s_cmp_ge_u32 s46, 128
    s_cbranch_scc1 L_f_done
    s_waitcnt vmcnt(7) lgkmcnt(0)
    v_readfirstlane_b32 s46, v29
    s_mov_b64 exec, 1
    ds_add_rtn_u32 v29, v27, v28
    s_mov_b64 exec, -1
    s_lshl_b32 s39, s46, 16
    s_mul_i32 s38, s46, 7168
    s_cmp_lt_u32 s46, 128
    s_cselect_b32 s39, s39, s41
    s_cselect_b32 s38, s38, s41
    s_add_u32 m0, s42, 0
    s_nop 0
    buffer_load_dwordx4 v4, s[24:27], s39 offen offset:0 lds
    buffer_load_dwordx4 v5, s[24:27], s39 offen offset:1024 lds
    buffer_load_dwordx4 v6, s[24:27], s39 offen offset:2048 lds
    buffer_load_dwordx4 v7, s[24:27], s39 offen offset:3072 lds
    ds_read_b64_tr_b16 v[216:217], v8 offset:4096
    ds_read_b64_tr_b16 v[218:219], v8 offset:5120
    ds_read_b64_tr_b16 v[220:221], v9 offset:4096
    ds_read_b64_tr_b16 v[222:223], v9 offset:5120
    ds_read_b64_tr_b16 v[224:225], v10 offset:4096
    ds_read_b64_tr_b16 v[226:227], v10 offset:5120
    ds_read_b64_tr_b16 v[228:229], v11 offset:4096
    ds_read_b64_tr_b16 v[230:231], v11 offset:5120
    v_mfma_f32_16x16x32_bf16 v[32:35], v[200:203], v[144:147], v[32:35]
    v_mfma_f32_16x16x32_bf16 v[36:39], v[204:207], v[144:147], v[36:39]
    v_mfma_f32_16x16x32_bf16 v[40:43], v[208:211], v[144:147], v[40:43]
    v_mfma_f32_16x16x32_bf16 v[44:47], v[212:215], v[144:147], v[44:47]
    v_mfma_f32_16x16x32_bf16 v[48:51], v[200:203], v[148:151], v[48:51]
    v_mfma_f32_16x16x32_bf16 v[52:55], v[204:207], v[148:151], v[52:55]
    v_mfma_f32_16x16x32_bf16 v[56:59], v[208:211], v[148:151], v[56:59]
    v_mfma_f32_16x16x32_bf16 v[60:63], v[212:215], v[148:151], v[60:63]
    v_mfma_f32_16x16x32_bf16 v[64:67], v[200:203], v[152:155], v[64:67]
    v_mfma_f32_16x16x32_bf16 v[68:71], v[204:207], v[152:155], v[68:71]
    v_mfma_f32_16x16x32_bf16 v[72:75], v[208:211], v[152:155], v[72:75]
    v_mfma_f32_16x16x32_bf16 v[76:79], v[212:215], v[152:155], v[76:79]
    v_mfma_f32_16x16x32_bf16 v[80:83], v[200:203], v[156:159], v[80:83]
    v_mfma_f32_16x16x32_bf16 v[84:87], v[204:207], v[156:159], v[84:87]
    v_mfma_f32_16x16x32_bf16 v[88:91], v[208:211], v[156:159], v[88:91]
    v_mfma_f32_16x16x32_bf16 v[92:95], v[212:215], v[156:159], v[92:95]
    v_mfma_f32_16x16x32_bf16 v[96:99], v[200:203], v[160:163], v[96:99]
    v_mfma_f32_16x16x32_bf16 v[100:103], v[204:207], v[160:163], v[100:103]
    v_mfma_f32_16x16x32_bf16 v[104:107], v[208:211], v[160:163], v[104:107]
    v_mfma_f32_16x16x32_bf16 v[108:111], v[212:215], v[160:163], v[108:111]
    v_mfma_f32_16x16x32_bf16 v[112:115], v[200:203], v[164:167], v[112:115]
    v_mfma_f32_16x16x32_bf16 v[116:119], v[204:207], v[164:167], v[116:119]
    v_mfma_f32_16x16x32_bf16 v[120:123], v[208:211], v[164:167], v[120:123]
    v_mfma_f32_16x16x32_bf16 v[124:127], v[212:215], v[164:167], v[124:127]
    v_mfma_f32_16x16x32_bf16 v[128:131], v[200:203], v[168:171], v[128:131]
    v_mfma_f32_16x16x32_bf16 v[132:135], v[204:207], v[168:171], v[132:135]
    v_mfma_f32_16x16x32_bf16 v[136:139], v[208:211], v[168:171], v[136:139]
    v_mfma_f32_16x16x32_bf16 v[140:143], v[212:215], v[168:171], v[140:143]
    buffer_load_dwordx4 v[144:147], v2, s[20:23], s38 offen offset:0
    buffer_load_dwordx4 v[148:151], v2, s[20:23], s38 offen offset:1024
    buffer_load_dwordx4 v[152:155], v2, s[20:23], s38 offen offset:2048
    buffer_load_dwordx4 v[156:159], v2, s[20:23], s38 offen offset:3072
    buffer_load_dwordx4 v[160:163], v3, s[20:23], s38 offen offset:0
    buffer_load_dwordx4 v[164:167], v3, s[20:23], s38 offen offset:1024
    buffer_load_dwordx4 v[168:171], v3, s[20:23], s38 offen offset:2048
    s_cmp_ge_u32 s47, 128
    s_cbranch_scc1 L_f_done
    s_waitcnt vmcnt(7) lgkmcnt(0)
    v_readfirstlane_b32 s47, v29
    s_mov_b64 exec, 1
    ds_add_rtn_u32 v29, v27, v28
    s_mov_b64 exec, -1
    s_lshl_b32 s39, s47, 16
    s_mul_i32 s38, s47, 7168
    s_cmp_lt_u32 s47, 128
    s_cselect_b32 s39, s39, s41
    s_cselect_b32 s38, s38, s41
    s_add_u32 m0, s42, 4096
    s_nop 0
    buffer_load_dwordx4 v4, s[24:27], s39 offen offset:0 lds
    buffer_load_dwordx4 v5, s[24:27], s39 offen offset:1024 lds
    buffer_load_dwordx4 v6, s[24:27], s39 offen offset:2048 lds
    buffer_load_dwordx4 v7, s[24:27], s39 offen offset:3072 lds
    ds_read_b64_tr_b16 v[200:201], v8 offset:0
    ds_read_b64_tr_b16 v[202:203], v8 offset:1024
    ds_read_b64_tr_b16 v[204:205], v9 offset:0
    ds_read_b64_tr_b16 v[206:207], v9 offset:1024
    ds_read_b64_tr_b16 v[208:209], v10 offset:0
    ds_read_b64_tr_b16 v[210:211], v10 offset:1024
    ds_read_b64_tr_b16 v[212:213], v11 offset:0
    ds_read_b64_tr_b16 v[214:215], v11 offset:1024
    v_mfma_f32_16x16x32_bf16 v[32:35], v[216:219], v[172:175], v[32:35]
    v_mfma_f32_16x16x32_bf16 v[36:39], v[220:223], v[172:175], v[36:39]
    v_mfma_f32_16x16x32_bf16 v[40:43], v[224:227], v[172:175], v[40:43]
    v_mfma_f32_16x16x32_bf16 v[44:47], v[228:231], v[172:175], v[44:47]
    v_mfma_f32_16x16x32_bf16 v[48:51], v[216:219], v[176:179], v[48:51]
    v_mfma_f32_16x16x32_bf16 v[52:55], v[220:223], v[176:179], v[52:55]
    v_mfma_f32_16x16x32_bf16 v[56:59], v[224:227], v[176:179], v[56:59]
    v_mfma_f32_16x16x32_bf16 v[60:63], v[228:231], v[176:179], v[60:63]
    v_mfma_f32_16x16x32_bf16 v[64:67], v[216:219], v[180:183], v[64:67]
    v_mfma_f32_16x16x32_bf16 v[68:71], v[220:223], v[180:183], v[68:71]
    v_mfma_f32_16x16x32_bf16 v[72:75], v[224:227], v[180:183], v[72:75]
    v_mfma_f32_16x16x32_bf16 v[76:79], v[228:231], v[180:183], v[76:79]
    v_mfma_f32_16x16x32_bf16 v[80:83], v[216:219], v[184:187], v[80:83]
    v_mfma_f32_16x16x32_bf16 v[84:87], v[220:223], v[184:187], v[84:87]
    v_mfma_f32_16x16x32_bf16 v[88:91], v[224:227], v[184:187], v[88:91]
    v_mfma_f32_16x16x32_bf16 v[92:95], v[228:231], v[184:187], v[92:95]
    v_mfma_f32_16x16x32_bf16 v[96:99], v[216:219], v[188:191], v[96:99]
    v_mfma_f32_16x16x32_bf16 v[100:103], v[220:223], v[188:191], v[100:103]
    v_mfma_f32_16x16x32_bf16 v[104:107], v[224:227], v[188:191], v[104:107]
    v_mfma_f32_16x16x32_bf16 v[108:111], v[228:231], v[188:191], v[108:111]
    v_mfma_f32_16x16x32_bf16 v[112:115], v[216:219], v[192:195], v[112:115]
    v_mfma_f32_16x16x32_bf16 v[116:119], v[220:223], v[192:195], v[116:119]
    v_mfma_f32_16x16x32_bf16 v[120:123], v[224:227], v[192:195], v[120:123]
    v_mfma_f32_16x16x32_bf16 v[124:127], v[228:231], v[192:195], v[124:127]
    v_mfma_f32_16x16x32_bf16 v[128:131], v[216:219], v[196:199], v[128:131]
    v_mfma_f32_16x16x32_bf16 v[132:135], v[220:223], v[196:199], v[132:135]
    v_mfma_f32_16x16x32_bf16 v[136:139], v[224:227], v[196:199], v[136:139]
    v_mfma_f32_16x16x32_bf16 v[140:143], v[228:231], v[196:199], v[140:143]
    buffer_load_dwordx4 v[172:175], v2, s[20:23], s38 offen offset:0
    buffer_load_dwordx4 v[176:179], v2, s[20:23], s38 offen offset:1024
    buffer_load_dwordx4 v[180:183], v2, s[20:23], s38 offen offset:2048
    buffer_load_dwordx4 v[184:187], v2, s[20:23], s38 offen offset:3072
    buffer_load_dwordx4 v[188:191], v3, s[20:23], s38 offen offset:0
    buffer_load_dwordx4 v[192:195], v3, s[20:23], s38 offen offset:1024
    buffer_load_dwordx4 v[196:199], v3, s[20:23], s38 offen offset:2048
    s_branch L_f_loop
L_f_done:
    s_nop 7
    s_waitcnt vmcnt(0) lgkmcnt(0)
    s_barrier
    s_lshl_b32 s4, s3, 10
    v_add_u32 v14, s4, v2
    v_add_u32 v15, 65536, v14
    v_lshlrev_b32 v16, 12, v13
    v_lshl_add_u32 v16, v12, 3, v16
    ds_write_b128 v14, v[32:35] offset:0
    ds_write_b128 v14, v[36:39] offset:8192
    ds_write_b128 v14, v[40:43] offset:16384
    ds_write_b128 v14, v[44:47] offset:24576
    ds_write_b128 v14, v[48:51] offset:32768
    ds_write_b128 v14, v[52:55] offset:40960
    ds_write_b128 v14, v[56:59] offset:49152
    ds_write_b128 v14, v[60:63] offset:57344
    ds_write_b128 v15, v[64:67] offset:0
    ds_write_b128 v15, v[68:71] offset:8192
    ds_write_b128 v15, v[72:75] offset:16384
    ds_write_b128 v15, v[76:79] offset:24576
    ds_write_b128 v15, v[80:83] offset:32768
    ds_write_b128 v15, v[84:87] offset:40960
    ds_write_b128 v15, v[88:91] offset:49152
    ds_write_b128 v15, v[92:95] offset:57344
    s_waitcnt lgkmcnt(0)
    s_barrier
    s_add_u32 s5, s3, 0
    s_lshl_b32 s4, s5, 13
    v_add_u32 v17, s4, v2
    ds_read_b128 v[144:147], v17 offset:0
    ds_read_b128 v[148:151], v17 offset:1024
    ds_read_b128 v[152:155], v17 offset:2048
    ds_read_b128 v[156:159], v17 offset:3072
    ds_read_b128 v[160:163], v17 offset:4096
    ds_read_b128 v[164:167], v17 offset:5120
    ds_read_b128 v[168:171], v17 offset:6144
    ds_read_b128 v[172:175], v17 offset:7168
    s_lshr_b32 s4, s5, 2
    s_add_u32 s4, s4, 0
    s_lshl_b32 s4, s4, 16
    s_and_b32 s5, s5, 3
    s_lshl_b32 s5, s5, 5
    s_add_u32 s4, s4, s5
    s_waitcnt lgkmcnt(0)
    v_add_f32 v144, v144, v148
    v_add_f32 v152, v152, v156
    v_add_f32 v160, v160, v164
    v_add_f32 v168, v168, v172
    v_add_f32 v144, v144, v152
    v_add_f32 v160, v160, v168
    v_add_f32 v144, v144, v160
    v_add_f32 v145, v145, v149
    v_add_f32 v153, v153, v157
    v_add_f32 v161, v161, v165
    v_add_f32 v169, v169, v173
    v_add_f32 v145, v145, v153
    v_add_f32 v161, v161, v169
    v_add_f32 v145, v145, v161
    v_add_f32 v146, v146, v150
    v_add_f32 v154, v154, v158
    v_add_f32 v162, v162, v166
    v_add_f32 v170, v170, v174
    v_add_f32 v146, v146, v154
    v_add_f32 v162, v162, v170
    v_add_f32 v146, v146, v162
    v_add_f32 v147, v147, v151
    v_add_f32 v155, v155, v159
    v_add_f32 v163, v163, v167
    v_add_f32 v171, v171, v175
    v_add_f32 v147, v147, v155
    v_add_f32 v163, v163, v171
    v_add_f32 v147, v147, v163
    v_cvt_pk_bf16_f32 v176, v144, v145
    v_cvt_pk_bf16_f32 v177, v146, v147
    buffer_store_dwordx2 v[176:177], v16, s[28:31], s4 offen nt
L_skip00:
    s_add_u32 s5, s3, 8
    s_lshl_b32 s4, s5, 13
    v_add_u32 v17, s4, v2
    ds_read_b128 v[144:147], v17 offset:0
    ds_read_b128 v[148:151], v17 offset:1024
    ds_read_b128 v[152:155], v17 offset:2048
    ds_read_b128 v[156:159], v17 offset:3072
    ds_read_b128 v[160:163], v17 offset:4096
    ds_read_b128 v[164:167], v17 offset:5120
    ds_read_b128 v[168:171], v17 offset:6144
    ds_read_b128 v[172:175], v17 offset:7168
    s_lshr_b32 s4, s5, 2
    s_add_u32 s4, s4, 0
    s_lshl_b32 s4, s4, 16
    s_and_b32 s5, s5, 3
    s_lshl_b32 s5, s5, 5
    s_add_u32 s4, s4, s5
    s_waitcnt lgkmcnt(0)
    v_add_f32 v144, v144, v148
    v_add_f32 v152, v152, v156
    v_add_f32 v160, v160, v164
    v_add_f32 v168, v168, v172
    v_add_f32 v144, v144, v152
    v_add_f32 v160, v160, v168
    v_add_f32 v144, v144, v160
    v_add_f32 v145, v145, v149
    v_add_f32 v153, v153, v157
    v_add_f32 v161, v161, v165
    v_add_f32 v169, v169, v173
    v_add_f32 v145, v145, v153
    v_add_f32 v161, v161, v169
    v_add_f32 v145, v145, v161
    v_add_f32 v146, v146, v150
    v_add_f32 v154, v154, v158
    v_add_f32 v162, v162, v166
    v_add_f32 v170, v170, v174
    v_add_f32 v146, v146, v154
    v_add_f32 v162, v162, v170
    v_add_f32 v146, v146, v162
    v_add_f32 v147, v147, v151
    v_add_f32 v155, v155, v159
    v_add_f32 v163, v163, v167
    v_add_f32 v171, v171, v175
    v_add_f32 v147, v147, v155
    v_add_f32 v163, v163, v171
    v_add_f32 v147, v147, v163
    v_cvt_pk_bf16_f32 v178, v144, v145
    v_cvt_pk_bf16_f32 v179, v146, v147
    buffer_store_dwordx2 v[178:179], v16, s[28:31], s4 offen nt
L_skip01:
    s_barrier
    ds_write_b128 v14, v[96:99] offset:0
    ds_write_b128 v14, v[100:103] offset:8192
    ds_write_b128 v14, v[104:107] offset:16384
    ds_write_b128 v14, v[108:111] offset:24576
    ds_write_b128 v14, v[112:115] offset:32768
    ds_write_b128 v14, v[116:119] offset:40960
    ds_write_b128 v14, v[120:123] offset:49152
    ds_write_b128 v14, v[124:127] offset:57344
    ds_write_b128 v15, v[128:131] offset:0
    ds_write_b128 v15, v[132:135] offset:8192
    ds_write_b128 v15, v[136:139] offset:16384
    ds_write_b128 v15, v[140:143] offset:24576
    s_waitcnt lgkmcnt(0)
    s_barrier
    s_add_u32 s5, s3, 0
    s_lshl_b32 s4, s5, 13
    v_add_u32 v17, s4, v2
    ds_read_b128 v[144:147], v17 offset:0
    ds_read_b128 v[148:151], v17 offset:1024
    ds_read_b128 v[152:155], v17 offset:2048
    ds_read_b128 v[156:159], v17 offset:3072
    ds_read_b128 v[160:163], v17 offset:4096
    ds_read_b128 v[164:167], v17 offset:5120
    ds_read_b128 v[168:171], v17 offset:6144
    ds_read_b128 v[172:175], v17 offset:7168
    s_lshr_b32 s4, s5, 2
    s_add_u32 s4, s4, 4
    s_lshl_b32 s4, s4, 16
    s_and_b32 s5, s5, 3
    s_lshl_b32 s5, s5, 5
    s_add_u32 s4, s4, s5
    s_waitcnt lgkmcnt(0)
    v_add_f32 v144, v144, v148
    v_add_f32 v152, v152, v156
    v_add_f32 v160, v160, v164
    v_add_f32 v168, v168, v172
    v_add_f32 v144, v144, v152
    v_add_f32 v160, v160, v168
    v_add_f32 v144, v144, v160
    v_add_f32 v145, v145, v149
    v_add_f32 v153, v153, v157
    v_add_f32 v161, v161, v165
    v_add_f32 v169, v169, v173
    v_add_f32 v145, v145, v153
    v_add_f32 v161, v161, v169
    v_add_f32 v145, v145, v161
    v_add_f32 v146, v146, v150
    v_add_f32 v154, v154, v158
    v_add_f32 v162, v162, v166
    v_add_f32 v170, v170, v174
    v_add_f32 v146, v146, v154
    v_add_f32 v162, v162, v170
    v_add_f32 v146, v146, v162
    v_add_f32 v147, v147, v151
    v_add_f32 v155, v155, v159
    v_add_f32 v163, v163, v167
    v_add_f32 v171, v171, v175
    v_add_f32 v147, v147, v155
    v_add_f32 v163, v163, v171
    v_add_f32 v147, v147, v163
    v_cvt_pk_bf16_f32 v180, v144, v145
    v_cvt_pk_bf16_f32 v181, v146, v147
    buffer_store_dwordx2 v[180:181], v16, s[28:31], s4 offen nt
L_skip10:
    s_cmp_ge_u32 s3, 4
    s_cbranch_scc1 L_skip11
    s_add_u32 s5, s3, 8
    s_lshl_b32 s4, s5, 13
    v_add_u32 v17, s4, v2
    ds_read_b128 v[144:147], v17 offset:0
    ds_read_b128 v[148:151], v17 offset:1024
    ds_read_b128 v[152:155], v17 offset:2048
    ds_read_b128 v[156:159], v17 offset:3072
    ds_read_b128 v[160:163], v17 offset:4096
    ds_read_b128 v[164:167], v17 offset:5120
    ds_read_b128 v[168:171], v17 offset:6144
    ds_read_b128 v[172:175], v17 offset:7168
    s_lshr_b32 s4, s5, 2
    s_add_u32 s4, s4, 4
    s_lshl_b32 s4, s4, 16
    s_and_b32 s5, s5, 3
    s_lshl_b32 s5, s5, 5
    s_add_u32 s4, s4, s5
    s_waitcnt lgkmcnt(0)
    v_add_f32 v144, v144, v148
    v_add_f32 v152, v152, v156
    v_add_f32 v160, v160, v164
    v_add_f32 v168, v168, v172
    v_add_f32 v144, v144, v152
    v_add_f32 v160, v160, v168
    v_add_f32 v144, v144, v160
    v_add_f32 v145, v145, v149
    v_add_f32 v153, v153, v157
    v_add_f32 v161, v161, v165
    v_add_f32 v169, v169, v173
    v_add_f32 v145, v145, v153
    v_add_f32 v161, v161, v169
    v_add_f32 v145, v145, v161
    v_add_f32 v146, v146, v150
    v_add_f32 v154, v154, v158
    v_add_f32 v162, v162, v166
    v_add_f32 v170, v170, v174
    v_add_f32 v146, v146, v154
    v_add_f32 v162, v162, v170
    v_add_f32 v146, v146, v162
    v_add_f32 v147, v147, v151
    v_add_f32 v155, v155, v159
    v_add_f32 v163, v163, v167
    v_add_f32 v171, v171, v175
    v_add_f32 v147, v147, v155
    v_add_f32 v163, v163, v171
    v_add_f32 v147, v147, v163
    v_cvt_pk_bf16_f32 v182, v144, v145
    v_cvt_pk_bf16_f32 v183, v146, v147
    buffer_store_dwordx2 v[182:183], v16, s[28:31], s4 offen nt
L_skip11:
L_attn_end:
    s_endpgm
.section .rodata,"a"
.p2align 6
.amdhsa_kernel attn_kernel
  .amdhsa_next_free_vgpr 256
  .amdhsa_next_free_sgpr 102
  .amdhsa_accum_offset 256
  .amdhsa_group_segment_fixed_size 0
  .amdhsa_kernarg_size 104
  .amdhsa_user_sgpr_count 2
  .amdhsa_user_sgpr_kernarg_segment_ptr 1
  .amdhsa_system_sgpr_workgroup_id_x 1
.end_amdhsa_kernel
```
